```python
import torch

def _softmax(x, axis=-1):
    return torch.softmax(x, dim=axis)
def _gelu(x):
    return torch.nn.functional.gelu(x, approximate="tanh")
def _silu(x):
    return torch.nn.functional.silu(x)
def _sigmoid(x):
    return torch.sigmoid(x)
def _layernorm(x, axis=-1, eps=1e-5):
    m = x.mean(dim=axis, keepdim=True)
    v = x.var(dim=axis, keepdim=True, unbiased=False)
    return (x - m) / torch.sqrt(v + eps)
def _scatter_add(tgt, idx, src, axis=0):
    return tgt.clone().index_add_(axis, idx, src)
def _segment_sum(src, seg, n):
    out = torch.zeros((n,) + src.shape[1:], dtype=src.dtype)
    return out.index_add_(0, seg, src)
def _pad(x, pw):
    flat = tuple(v for pair in reversed(pw) for v in pair)
    return torch.nn.functional.pad(x, flat)

kernel_name = 'gated_mix__linear_attn_block__ssm_conv_s4d__prompt'

def setup_inputs():

    _w = (lambda a: (lambda t: t.to(torch.bfloat16) if t.is_floating_point() else t)(torch.as_tensor(a)))
    def _A_setup():
        B, S, D = 1, 2048, 1024
        return {
            "x": _w((lambda *s: torch.randn(*s, dtype=torch.bfloat16) * 0.05)(B, S, D)),
            "wqkv": _w((lambda *s: torch.randn(*s, dtype=torch.bfloat16) * 0.8)(D, 3 * D)),
            "wo": _w((lambda *s: torch.randn(*s, dtype=torch.bfloat16) * 0.05)(D, D)),
        }
    _A_in = _A_setup()

    def _B_setup():
        Bsz, L, D, N = 1, 2048, 1024, 128
        return {
            "u": _w((lambda *s: torch.randn(*s, dtype=torch.bfloat16) * 0.05)(Bsz, L, D)),
            "log_A_real": _w((lambda *s: torch.randn(*s, dtype=torch.bfloat16) * 3.2)(D, N) * 0.5),
            "A_imag": _w((lambda *s: torch.randn(*s, dtype=torch.bfloat16) * 0.05)(D, N) * 3.14),
            "C_real": _w((lambda *s: torch.randn(*s, dtype=torch.bfloat16) * 0.8)(D, N) / N ** 0.5),
            "C_imag": _w((lambda *s: torch.randn(*s, dtype=torch.bfloat16) * 0.8)(D, N) / N ** 0.5),
            "log_dt": _w((lambda *s: torch.randn(*s, dtype=torch.bfloat16) * 0.05)(D) * 0.5 - 4.0),
            "D_skip": _w((lambda *s: torch.randn(*s, dtype=torch.bfloat16) * 0.1)(D)),
        }
    _B_in = _B_setup()

    return {
        "A_x": _A_in["x"],
        "A_wqkv": _A_in["wqkv"],
        "A_wo": _A_in["wo"],
        "B_u": _B_in["u"],
        "B_log_A_real": _B_in["log_A_real"],
        "B_A_imag": _B_in["A_imag"],
        "B_C_real": _B_in["C_real"],
        "B_C_imag": _B_in["C_imag"],
        "B_log_dt": _B_in["log_dt"],
        "B_D_skip": _B_in["D_skip"],
        "gate_w": _w((lambda *s: torch.randn(*s, dtype=torch.bfloat16) * 0.05)(1024) * 16.0),
    }

def reference(A_x, A_wqkv, A_wo, B_u, B_log_A_real, B_A_imag, B_C_real, B_C_imag, B_log_dt, B_D_skip, gate_w):
    def _A_ref(x, wqkv, wo):
        B, S, D = x.shape
        H = 32; Dh = D // H
        qkv = (lambda x, *d: x.permute(*d))((x @ wqkv).reshape(B, S, 3, H, Dh), 2, 0, 3, 1, 4)
        q, k, v = qkv[0], qkv[1], qkv[2]
        phi = lambda t: torch.where(t > 0, t + 1, torch.exp(t)) + 1e-6
        pq, pk = phi(q), phi(k)
        kv = torch.einsum("bhsd,bhse->bhde", pk, v)
        z = torch.einsum("bhsd->bhd", pk)
        num = torch.einsum("bhqd,bhde->bhqe", pq, kv)
        den = torch.einsum("bhqd,bhd->bhq", pq, z)[..., None] + 1e-6
        o = num / den
        return (lambda x, *d: x.permute(*d))(o, 0, 2, 1, 3).reshape(B, S, D) @ wo

    def _B_ref(u, log_A_real, A_imag, C_real, C_imag, log_dt, D_skip):
        L = u.shape[1]
        dt = torch.exp(log_dt)
        A = -torch.exp(log_A_real) + 1j * A_imag
        C = (C_real + 1j * C_imag) * dt[:, None]
        pos = (lambda x, dt: x.to(dt))(torch.arange(L), log_dt.dtype)
        P = torch.exp((A * dt[:, None])[:, :, None] * pos[None, None, :])
        K = 2.0 * torch.einsum("dn,dnl->dl", C, P).real
        L2 = 2 * L
        u_t = (lambda x, *d: x.permute(*d))(u, 0, 2, 1)
        Kf = (lambda x, *a, **k: torch.fft.rfft(x.float(), *a, **k))(K, L2)
        Uf = (lambda x, *a, **k: torch.fft.rfft(x.float(), *a, **k))(u_t, L2)
        y = (lambda x, *a, **k: torch.fft.irfft(x, *a, **k).to(torch.bfloat16))(Uf * Kf[None, :, :], L2)[:, :, :L]
        y = (lambda x, *d: x.permute(*d))(y, 0, 2, 1)
        return y + u * D_skip[None, None, :]

    x = A_x
    g = _sigmoid((x * gate_w).sum(-1, keepdims=True))
    a = _A_ref(x, A_wqkv, A_wo)
    b = _B_ref(x, B_log_A_real, B_A_imag, B_C_real, B_C_imag, B_log_dt, B_D_skip)
    return g * a + (1 - g) * b
```

```asm
; @launch grid=(256,1,1) block=(512,1,1) lds=163840
.amdgcn_target "amdgcn-amd-amdhsa--gfx950"
.text
.globl gated_mix__linear_attn_block__ssm_conv_s4d__prompt_kernel
.p2align 8
.type gated_mix__linear_attn_block__ssm_conv_s4d__prompt_kernel,@function
gated_mix__linear_attn_block__ssm_conv_s4d__prompt_kernel:
    s_cmp_ge_u32 s2, 256
    s_cbranch_scc1 L_end
    s_load_dwordx4 s[4:7], s[0:1], 0
    s_load_dwordx2 s[20:21], s[0:1], 104
    v_lshrrev_b32 v1, 6, v0
    v_and_b32 v0, 63, v0
    v_readfirstlane_b32 s31, v1
    s_and_b32 s33, s2, 7
    s_lshr_b32 s34, s2, 3
    s_and_b32 s35, s33, 1
    s_lshl_b32 s35, s35, 3
    s_and_b32 s36, s34, 7
    s_add_u32 s35, s35, s36
    s_lshr_b32 s36, s33, 1
    s_lshl_b32 s36, s36, 2
    s_lshr_b32 s37, s34, 3
    s_add_u32 s36, s36, s37
    s_cmp_ge_u32 s31, 4
    s_cbranch_scc1 L_h
    s_load_dwordx2 s[22:23], s[0:1], 16
    s_load_dwordx2 s[48:49], s[0:1], 88
    s_load_dwordx2 s[72:73], s[0:1], 80
    s_lshl_b32 s37, s35, 7
    s_lshl_b32 s38, s31, 5
    s_add_u32 s37, s37, s38
    v_lshrrev_b32 v4, 3, v0
    v_add_u32 v4, s37, v4
    v_lshlrev_b32 v4, 11, v4
    v_and_b32 v5, 7, v0
    v_lshrrev_b32 v6, 4, v0
    v_xor_b32 v7, v5, v6
    v_xor_b32 v8, 4, v7
    v_lshl_add_u32 v7, v7, 4, v4
    v_lshl_add_u32 v8, v8, 4, v4
    v_add_u32 v176, 0, v7
    v_add_u32 v177, 15360, v8
    v_add_u32 v178, 30720, v7
    v_add_u32 v179, 46080, v8
    s_lshl_b32 s38, s31, 4
    v_lshrrev_b32 v4, 3, v0
    v_add_u32 v4, s38, v4
    v_mul_u32_u24 v4, 6144, v4
    v_and_b32 v6, 1, v6
    v_lshlrev_b32 v6, 2, v6
    v_xor_b32 v7, v5, v6
    v_lshl_add_u32 v7, v7, 4, v4
    s_lshl_b32 s38, s36, 7
    v_add_u32 v180, s38, v7
    v_add_u32 v181, 48128, v180
    v_xor_b32 v182, 128, v180
    v_xor_b32 v183, 128, v181
    s_lshl_b32 s39, s31, 12
    s_lshl_b32 s40, s31, 11
    s_add_u32 s40, s40, 16384
    s_and_b32 s26, s36, 8
    s_lshl_b32 s26, s26, 7
    s_mul_i32 s27, s26, 3072
    s_mov_b32 s29, 0
    s_waitcnt lgkmcnt(0)
    s_mov_b32 s8, s4
    s_mov_b32 s9, s5
    s_mov_b32 s10, 0x400000
    s_mov_b32 s11, 0x00020000
    s_mov_b32 s12, s6
    s_mov_b32 s13, s7
    s_mov_b32 s14, 0x600000
    s_mov_b32 s15, 0x00020000
    s_mov_b32 s16, s20
    s_mov_b32 s17, s21
    s_mov_b32 s18, 0x10000000
    s_mov_b32 s19, 0x00020000
    s_add_u32 m0, s29, s39
    s_nop 0
    buffer_load_dwordx4 v176, s[8:11], s26 offen offset:0 lds
    buffer_load_dwordx4 v177, s[8:11], s26 offen offset:1024 lds
    buffer_load_dwordx4 v178, s[8:11], s26 offen offset:2048 lds
    buffer_load_dwordx4 v179, s[8:11], s26 offen offset:3072 lds
    s_add_u32 s25, s29, s40
    s_mov_b32 m0, s25
    s_mov_b32 s32, s27
    buffer_load_dwordx4 v182, s[12:15], s32 offen offset:0 lds
    buffer_load_dwordx4 v183, s[12:15], s32 offen offset:1024 lds
    s_add_u32 m0, s25, 8192
    s_add_u32 s32, s27, 2048
    buffer_load_dwordx4 v180, s[12:15], s32 offen offset:0 lds
    buffer_load_dwordx4 v181, s[12:15], s32 offen offset:1024 lds
    s_add_u32 m0, s25, 16384
    s_add_u32 s32, s27, 4096
    buffer_load_dwordx4 v180, s[12:15], s32 offen offset:0 lds
    buffer_load_dwordx4 v181, s[12:15], s32 offen offset:1024 lds
    s_add_u32 s26, s26, 128
    s_and_b32 s26, s26, 2047
    s_mul_i32 s27, s26, 3072
    s_add_u32 s29, s29, 40960
    s_cmp_eq_u32 s29, 122880
    s_cselect_b32 s29, 0, s29
    s_add_u32 m0, s29, s39
    s_nop 0
    buffer_load_dwordx4 v176, s[8:11], s26 offen offset:0 lds
    v_mov_b32 v9, 0x358637bd
    v_mov_b32 v40, v9
    v_mov_b32 v41, v9
    v_mov_b32 v42, v9
    v_mov_b32 v43, v9
    v_mov_b32 v44, v9
    v_mov_b32 v45, v9
    v_mov_b32 v46, v9
    v_mov_b32 v47, v9
    v_mov_b32 v48, v9
    v_mov_b32 v49, v9
    v_mov_b32 v50, v9
    buffer_load_dwordx4 v177, s[8:11], s26 offen offset:1024 lds
    v_mov_b32 v51, v9
    v_mov_b32 v52, v9
    v_mov_b32 v53, v9
    v_mov_b32 v54, v9
    v_mov_b32 v55, v9
    v_mov_b32 v56, v9
    v_mov_b32 v57, v9
    v_mov_b32 v58, v9
    v_mov_b32 v59, v9
    v_mov_b32 v60, v9
    v_mov_b32 v61, v9
    v_mov_b32 v62, v9
    buffer_load_dwordx4 v178, s[8:11], s26 offen offset:2048 lds
    v_mov_b32 v63, v9
    v_mov_b32 v64, v9
    v_mov_b32 v65, v9
    v_mov_b32 v66, v9
    v_mov_b32 v67, v9
    v_mov_b32 v68, v9
    v_mov_b32 v69, v9
    v_mov_b32 v70, v9
    v_mov_b32 v71, v9
    v_mov_b32 v72, v9
    v_mov_b32 v73, v9
    v_mov_b32 v74, v9
    buffer_load_dwordx4 v179, s[8:11], s26 offen offset:3072 lds
    v_mov_b32 v75, v9
    v_mov_b32 v76, v9
    v_mov_b32 v77, v9
    v_mov_b32 v78, v9
    v_mov_b32 v79, v9
    v_mov_b32 v80, v9
    v_mov_b32 v81, v9
    v_mov_b32 v82, v9
    v_mov_b32 v83, v9
    v_mov_b32 v84, v9
    v_mov_b32 v85, v9
    v_mov_b32 v86, v9
    s_add_u32 s25, s29, s40
    s_mov_b32 m0, s25
    s_mov_b32 s32, s27
    buffer_load_dwordx4 v182, s[12:15], s32 offen offset:0 lds
    v_mov_b32 v87, v9
    v_mov_b32 v88, v9
    v_mov_b32 v89, v9
    v_mov_b32 v90, v9
    v_mov_b32 v91, v9
    v_mov_b32 v92, v9
    v_mov_b32 v93, v9
    v_mov_b32 v94, v9
    v_mov_b32 v95, v9
    v_mov_b32 v96, v9
    v_mov_b32 v97, v9
    v_mov_b32 v98, v9
    buffer_load_dwordx4 v183, s[12:15], s32 offen offset:1024 lds
    v_mov_b32 v99, v9
    v_mov_b32 v100, v9
    v_mov_b32 v101, v9
    v_mov_b32 v102, v9
    v_mov_b32 v103, v9
    v_mov_b32 v104, 0
    v_mov_b32 v105, 0
    v_mov_b32 v106, 0
    v_mov_b32 v107, 0
    v_mov_b32 v108, 0
    v_mov_b32 v109, 0
    v_mov_b32 v110, 0
    s_add_u32 m0, s25, 8192
    s_add_u32 s32, s27, 2048
    buffer_load_dwordx4 v180, s[12:15], s32 offen offset:0 lds
    v_mov_b32 v111, 0
    v_mov_b32 v112, 0
    v_mov_b32 v113, 0
    v_mov_b32 v114, 0
    v_mov_b32 v115, 0
    v_mov_b32 v116, 0
    v_mov_b32 v117, 0
    v_mov_b32 v118, 0
    v_mov_b32 v119, 0
    v_mov_b32 v120, 0
    v_mov_b32 v121, 0
    v_mov_b32 v122, 0
    buffer_load_dwordx4 v181, s[12:15], s32 offen offset:1024 lds
    v_mov_b32 v123, 0
    v_mov_b32 v124, 0
    v_mov_b32 v125, 0
    v_mov_b32 v126, 0
    v_mov_b32 v127, 0
    v_mov_b32 v128, 0
    v_mov_b32 v129, 0
    v_mov_b32 v130, 0
    v_mov_b32 v131, 0
    v_mov_b32 v132, 0
    v_mov_b32 v133, 0
    v_mov_b32 v134, 0
    s_add_u32 m0, s25, 16384
    s_add_u32 s32, s27, 4096
    buffer_load_dwordx4 v180, s[12:15], s32 offen offset:0 lds
    v_mov_b32 v135, 0
    v_mov_b32 v156, 0
    v_mov_b32 v157, 0
    v_mov_b32 v158, 0
    v_mov_b32 v159, 0
    v_mov_b32 v160, 0
    v_mov_b32 v161, 0
    v_mov_b32 v162, 0
    v_mov_b32 v163, 0
    v_mov_b32 v164, 0
    v_mov_b32 v165, 0
    v_mov_b32 v166, 0
    buffer_load_dwordx4 v181, s[12:15], s32 offen offset:1024 lds
    v_mov_b32 v167, 0
    v_mov_b32 v168, 0
    v_mov_b32 v169, 0
    v_mov_b32 v170, 0
    v_mov_b32 v171, 0
    v_mov_b32 v172, 0
    v_mov_b32 v173, 0
    v_mov_b32 v174, 0
    v_mov_b32 v175, 0
    s_add_u32 s26, s26, 128
    s_and_b32 s26, s26, 2047
    s_mul_i32 s27, s26, 3072
    s_add_u32 s29, s29, 40960
    s_cmp_eq_u32 s29, 122880
    s_cselect_b32 s29, 0, s29
    s_and_b32 s38, s31, 1
    s_lshl_b32 s38, s38, 13
    v_and_b32 v4, 31, v0
    v_lshrrev_b32 v5, 5, v0
    v_bfe_u32 v6, v0, 1, 3
    v_xor_b32 v6, v6, v5
    v_lshlrev_b32 v6, 4, v6
    v_lshl_add_u32 v6, v4, 7, v6
    v_add_u32 v184, s38, v6
    v_xor_b32 v185, 32, v184
    v_xor_b32 v186, 64, v184
    v_xor_b32 v187, 96, v184
    s_lshr_b32 s38, s31, 1
    s_lshl_b32 s38, s38, 2
    v_bfe_u32 v4, v0, 2, 2
    v_lshl_add_u32 v7, v5, 3, v4
    v_bfe_u32 v6, v0, 4, 1
    v_lshlrev_b32 v6, 1, v6
    v_bfe_u32 v8, v0, 1, 1
    v_add3_u32 v6, v6, v8, s38
    v_bfe_u32 v8, v0, 3, 1
    v_lshlrev_b32 v8, 2, v8
    v_xor_b32 v6, v6, v8
    v_lshlrev_b32 v6, 4, v6
    v_lshl_add_u32 v6, v7, 7, v6
    v_and_b32 v8, 1, v0
    v_lshl_add_u32 v6, v8, 3, v6
    v_add_u32 v188, 16384, v6
    v_mov_b32 v9, 0x358637bd
    v_lshlrev_b32 v10, 4, v0
    v_lshlrev_b32 v11, 2, v0
    s_xor_b32 s88, s36, 1
    s_lshl_b32 s88, s88, 1
    s_lshr_b32 s38, s31, 1
    s_add_u32 s88, s88, s38
    s_lshl_b32 s89, s35, 1
    s_and_b32 s38, s31, 1
    s_add_u32 s89, s89, s38
    s_lshl_b32 s86, s89, 6
    s_add_u32 s86, s86, s88
    s_lshl_b32 s86, s86, 11
    s_add_u32 s87, s86, 65536
    s_lshl_b32 s84, s89, 6
    s_lshl_b32 s38, s88, 1
    s_add_u32 s84, s84, s38
    s_lshl_b32 s85, s84, 11
    s_lshl_b32 s84, s84, 2
    s_add_u32 s84, s84, 12779520
    s_mov_b32 s28, 0
    s_mov_b32 s30, 0
    v_mov_b32 v189, v184
    v_mov_b32 v190, v185
    v_mov_b32 v191, v186
    v_mov_b32 v192, v187
    v_mov_b32 v193, v188
L_loop:
    s_waitcnt vmcnt(10) lgkmcnt(0)
    s_barrier
    v_mfma_f32_32x32x16_bf16 v[40:55], v[164:167], v[156:159], v[40:55]
    ds_read_b128 v[136:139], v189 offset:0
    ds_read_b128 v[140:143], v189 offset:4096
    ds_read_b64_tr_b16 v[144:145], v193 offset:0
    v_mfma_f32_32x32x16_bf16 v[72:87], v[156:159], v[168:171], v[72:87]
    ds_read_b64_tr_b16 v[146:147], v193 offset:512
    ds_read_b64_tr_b16 v[148:149], v193 offset:8192
    ds_read_b64_tr_b16 v[150:151], v193 offset:8704
    v_mfma_f32_32x32x16_bf16 v[104:119], v[156:159], v[172:175], v[104:119]
    ds_read_b64_tr_b16 v[152:153], v193 offset:16384
    ds_read_b64_tr_b16 v[154:155], v193 offset:16896
    s_add_u32 m0, s29, s39
    s_nop 0
    buffer_load_dwordx4 v176, s[8:11], s26 offen offset:0 lds
    v_mfma_f32_32x32x16_bf16 v[56:71], v[164:167], v[160:163], v[56:71]
    buffer_load_dwordx4 v177, s[8:11], s26 offen offset:1024 lds
    v_mfma_f32_32x32x16_bf16 v[88:103], v[160:163], v[168:171], v[88:103]
    buffer_load_dwordx4 v178, s[8:11], s26 offen offset:2048 lds
    v_mfma_f32_32x32x16_bf16 v[120:135], v[160:163], v[172:175], v[120:135]
    s_waitcnt lgkmcnt(0)
    v_mfma_f32_32x32x16_bf16 v[40:55], v[144:147], v[136:139], v[40:55]
    ds_read_b128 v[156:159], v190 offset:0
    ds_read_b128 v[160:163], v190 offset:4096
    ds_read_b64_tr_b16 v[164:165], v193 offset:2048
    v_mfma_f32_32x32x16_bf16 v[72:87], v[136:139], v[148:151], v[72:87]
    ds_read_b64_tr_b16 v[166:167], v193 offset:2560
    ds_read_b64_tr_b16 v[168:169], v193 offset:10240
    ds_read_b64_tr_b16 v[170:171], v193 offset:10752
    v_mfma_f32_32x32x16_bf16 v[104:119], v[136:139], v[152:155], v[104:119]
    ds_read_b64_tr_b16 v[172:173], v193 offset:18432
    ds_read_b64_tr_b16 v[174:175], v193 offset:18944
    buffer_load_dwordx4 v179, s[8:11], s26 offen offset:3072 lds
    v_mfma_f32_32x32x16_bf16 v[56:71], v[144:147], v[140:143], v[56:71]
    s_add_u32 s25, s29, s40
    s_mov_b32 m0, s25
    s_mov_b32 s32, s27
    buffer_load_dwordx4 v182, s[12:15], s32 offen offset:0 lds
    v_mfma_f32_32x32x16_bf16 v[88:103], v[140:143], v[148:151], v[88:103]
    buffer_load_dwordx4 v183, s[12:15], s32 offen offset:1024 lds
    v_mfma_f32_32x32x16_bf16 v[120:135], v[140:143], v[152:155], v[120:135]
    s_waitcnt lgkmcnt(0)
    v_mfma_f32_32x32x16_bf16 v[40:55], v[164:167], v[156:159], v[40:55]
    ds_read_b128 v[136:139], v191 offset:0
    ds_read_b128 v[140:143], v191 offset:4096
    ds_read_b64_tr_b16 v[144:145], v193 offset:4096
    v_mfma_f32_32x32x16_bf16 v[72:87], v[156:159], v[168:171], v[72:87]
    ds_read_b64_tr_b16 v[146:147], v193 offset:4608
    ds_read_b64_tr_b16 v[148:149], v193 offset:12288
    ds_read_b64_tr_b16 v[150:151], v193 offset:12800
    v_mfma_f32_32x32x16_bf16 v[104:119], v[156:159], v[172:175], v[104:119]
    ds_read_b64_tr_b16 v[152:153], v193 offset:20480
    ds_read_b64_tr_b16 v[154:155], v193 offset:20992
    s_add_u32 m0, s25, 8192
    s_add_u32 s32, s27, 2048
    buffer_load_dwordx4 v180, s[12:15], s32 offen offset:0 lds
    v_mfma_f32_32x32x16_bf16 v[56:71], v[164:167], v[160:163], v[56:71]
    buffer_load_dwordx4 v181, s[12:15], s32 offen offset:1024 lds
    v_mfma_f32_32x32x16_bf16 v[88:103], v[160:163], v[168:171], v[88:103]
    s_add_u32 m0, s25, 16384
    s_add_u32 s32, s27, 4096
    buffer_load_dwordx4 v180, s[12:15], s32 offen offset:0 lds
    v_mfma_f32_32x32x16_bf16 v[120:135], v[160:163], v[172:175], v[120:135]
    s_waitcnt lgkmcnt(0)
    v_mfma_f32_32x32x16_bf16 v[40:55], v[144:147], v[136:139], v[40:55]
    ds_read_b128 v[156:159], v192 offset:0
    ds_read_b128 v[160:163], v192 offset:4096
    ds_read_b64_tr_b16 v[164:165], v193 offset:6144
    v_mfma_f32_32x32x16_bf16 v[72:87], v[136:139], v[148:151], v[72:87]
    ds_read_b64_tr_b16 v[166:167], v193 offset:6656
    ds_read_b64_tr_b16 v[168:169], v193 offset:14336
    ds_read_b64_tr_b16 v[170:171], v193 offset:14848
    v_mfma_f32_32x32x16_bf16 v[104:119], v[136:139], v[152:155], v[104:119]
    ds_read_b64_tr_b16 v[172:173], v193 offset:22528
    ds_read_b64_tr_b16 v[174:175], v193 offset:23040
    buffer_load_dwordx4 v181, s[12:15], s32 offen offset:1024 lds
    v_mfma_f32_32x32x16_bf16 v[56:71], v[144:147], v[140:143], v[56:71]
    s_add_u32 s26, s26, 128
    s_and_b32 s26, s26, 2047
    s_mul_i32 s27, s26, 3072
    s_add_u32 s29, s29, 40960
    s_cmp_eq_u32 s29, 122880
    s_cselect_b32 s29, 0, s29
    s_add_u32 s28, s28, 40960
    s_cmp_eq_u32 s28, 122880
    s_cselect_b32 s28, 0, s28
    v_mfma_f32_32x32x16_bf16 v[88:103], v[140:143], v[148:151], v[88:103]
    v_add_u32 v189, s28, v184
    v_add_u32 v190, s28, v185
    v_add_u32 v191, s28, v186
    v_add_u32 v192, s28, v187
    v_add_u32 v193, s28, v188
    s_add_u32 s30, s30, 1
    s_cmp_lt_u32 s30, 14
    v_mfma_f32_32x32x16_bf16 v[120:135], v[140:143], v[152:155], v[120:135]
    s_cbranch_scc1 L_loop
    s_waitcnt vmcnt(10) lgkmcnt(0)
    s_barrier
    v_mfma_f32_32x32x16_bf16 v[40:55], v[164:167], v[156:159], v[40:55]
    ds_read_b128 v[136:139], v189 offset:0
    ds_read_b128 v[140:143], v189 offset:4096
    ds_read_b64_tr_b16 v[144:145], v193 offset:0
    s_mov_b32 s42, 0x3fb8aa3b
    s_mov_b32 s44, 0x358637bd
    s_mul_i32 s45, s31, 5120
    s_add_u32 s45, s45, 59392
    v_add_u32 v3, s45, v10
    v_mfma_f32_32x32x16_bf16 v[72:87], v[156:159], v[168:171], v[72:87]
    ds_read_b64_tr_b16 v[146:147], v193 offset:512
    ds_read_b64_tr_b16 v[148:149], v193 offset:8192
    ds_read_b64_tr_b16 v[150:151], v193 offset:8704
    s_lshr_b32 s46, s31, 1
    s_and_b32 s47, s31, 1
    s_mul_i32 s50, s46, 10240
    s_add_u32 s50, s50, 59392
    v_add_u32 v4, s50, v10
    v_mfma_f32_32x32x16_bf16 v[104:119], v[156:159], v[172:175], v[104:119]
    ds_read_b64_tr_b16 v[152:153], v193 offset:16384
    ds_read_b64_tr_b16 v[154:155], v193 offset:16896
    s_lshl_b32 s51, s47, 11
    s_add_u32 s50, s50, s51
    v_add_u32 v5, s50, v11
    s_lshl_b32 s41, s36, 1
    s_add_u32 s41, s41, s46
    v_mfma_f32_32x32x16_bf16 v[56:71], v[164:167], v[160:163], v[56:71]
    s_lshl_b32 s52, s41, 7
    s_add_u32 s52, s52, 12713984
    s_lshl_b32 s53, s41, 12
    s_add_u32 s53, s53, 12582912
    s_add_u32 s54, s53, s51
    v_mfma_f32_32x32x16_bf16 v[88:103], v[160:163], v[168:171], v[88:103]
    v_mov_b32 v8, 163592
    v_mov_b32 v7, 1
    v_mov_b32 v212, 0x3f803f80
    v_mov_b32 v213, 0x3f803f80
    v_mov_b32 v214, 0x3f803f80
    v_mfma_f32_32x32x16_bf16 v[120:135], v[160:163], v[172:175], v[120:135]
    v_mov_b32 v215, 0x3f803f80
    s_mov_b32 s80, s22
    s_mov_b32 s81, s23
    s_mov_b32 s82, 0x200000
    s_mov_b32 s83, 0x00020000
    s_waitcnt lgkmcnt(0)
    v_mfma_f32_32x32x16_bf16 v[40:55], v[144:147], v[136:139], v[40:55]
    ds_read_b128 v[156:159], v190 offset:0
    ds_read_b128 v[160:163], v190 offset:4096
    ds_read_b64_tr_b16 v[164:165], v193 offset:2048
    s_mov_b32 s76, s48
    s_mov_b32 s77, s49
    s_mov_b32 s78, 0x400000
    s_mov_b32 s79, 0x00020000
    v_mov_b32 v36, 163584
    v_mfma_f32_32x32x16_bf16 v[72:87], v[136:139], v[148:151], v[72:87]
    ds_read_b64_tr_b16 v[166:167], v193 offset:2560
    ds_read_b64_tr_b16 v[168:169], v193 offset:10240
    ds_read_b64_tr_b16 v[170:171], v193 offset:10752
    v_mov_b32 v14, 1
    s_mov_b32 s58, 0
    v_lshrrev_b32 v16, 5, v0
    v_lshlrev_b32 v16, 4, v16
    s_lshl_b32 s91, s88, 7
    v_mfma_f32_32x32x16_bf16 v[104:119], v[136:139], v[152:155], v[104:119]
    ds_read_b64_tr_b16 v[172:173], v193 offset:18432
    ds_read_b64_tr_b16 v[174:175], v193 offset:18944
    s_add_u32 s91, s91, 12713984
    s_lshl_b32 s92, s88, 12
    s_add_u32 s92, s92, 12582912
    s_lshl_b32 s59, s88, 9
    s_and_b32 s60, s35, 3
    v_mfma_f32_32x32x16_bf16 v[56:71], v[144:147], v[140:143], v[56:71]
    s_lshl_b32 s60, s60, 7
    s_add_u32 s59, s59, s60
    s_add_u32 s59, s59, 12845056
    s_lshl_b32 s60, s41, 9
    s_add_u32 s60, s60, 12845056
    v_mfma_f32_32x32x16_bf16 v[88:103], v[140:143], v[148:151], v[88:103]
    s_and_b32 s33, s2, 7
    s_lshr_b32 s34, s2, 3
    s_and_b32 s56, s33, 3
    s_lshl_b32 s56, s56, 2
    s_and_b32 s37, s34, 3
    v_mfma_f32_32x32x16_bf16 v[120:135], v[140:143], v[152:155], v[120:135]
    s_add_u32 s56, s56, s37
    s_lshr_b32 s57, s33, 2
    s_lshl_b32 s57, s57, 3
    s_lshr_b32 s37, s34, 2
    s_add_u32 s57, s57, s37
    s_waitcnt lgkmcnt(0)
    v_mfma_f32_32x32x16_bf16 v[40:55], v[164:167], v[156:159], v[40:55]
    ds_read_b128 v[136:139], v191 offset:0
    ds_read_b128 v[140:143], v191 offset:4096
    ds_read_b64_tr_b16 v[144:145], v193 offset:4096
    s_lshl_b32 s33, s31, 5
    v_lshrrev_b32 v2, 3, v0
    v_add_u32 v2, s33, v2
    v_lshlrev_b32 v2, 11, v2
    v_and_b32 v6, 7, v0
    v_mfma_f32_32x32x16_bf16 v[72:87], v[156:159], v[168:171], v[72:87]
    ds_read_b64_tr_b16 v[146:147], v193 offset:4608
    ds_read_b64_tr_b16 v[148:149], v193 offset:12288
    ds_read_b64_tr_b16 v[150:151], v193 offset:12800
    v_bfe_u32 v9, v0, 4, 1
    v_lshlrev_b32 v9, 2, v9
    v_xor_b32 v6, v6, v9
    v_lshl_add_u32 v12, v6, 4, v2
    s_lshl_b32 s90, s57, 7
    v_mfma_f32_32x32x16_bf16 v[104:119], v[156:159], v[172:175], v[104:119]
    ds_read_b64_tr_b16 v[152:153], v193 offset:20480
    ds_read_b64_tr_b16 v[154:155], v193 offset:20992
    s_lshl_b32 s62, s31, 12
    s_lshl_b32 s63, s56, 2
    s_add_u32 s63, s63, s31
    s_lshr_b32 s65, s63, 1
    s_lshl_b32 s74, s65, 9
    v_mfma_f32_32x32x16_bf16 v[56:71], v[164:167], v[160:163], v[56:71]
    s_and_b32 s33, s57, 3
    s_lshl_b32 s33, s33, 7
    s_add_u32 s74, s74, s33
    s_add_u32 s74, s74, 12861440
    s_lshl_b32 s65, s56, 7
    v_mfma_f32_32x32x16_bf16 v[88:103], v[160:163], v[168:171], v[88:103]
    s_add_u32 s65, s65, 12877824
    s_lshl_b32 s63, s63, 16
    s_lshl_b32 s75, s89, 9
    s_add_u32 s75, s75, 12861440
    v_lshlrev_b32 v13, 7, v0
    v_mfma_f32_32x32x16_bf16 v[120:135], v[160:163], v[172:175], v[120:135]
    v_mov_b32 v15, 0
    s_lshl_b32 s66, s57, 18
    s_lshl_b32 s33, s56, 8
    s_add_u32 s66, s66, s33
    s_lshl_b32 s33, s31, 6
    s_waitcnt lgkmcnt(0)
    v_mfma_f32_32x32x16_bf16 v[40:55], v[144:147], v[136:139], v[40:55]
    ds_read_b128 v[156:159], v192 offset:0
    ds_read_b128 v[160:163], v192 offset:4096
    ds_read_b64_tr_b16 v[164:165], v193 offset:6144
    s_add_u32 s66, s66, s33
    s_add_u32 s66, s66, 8388608
    s_lshl_b32 s67, s56, 9
    s_lshl_b32 s33, s31, 7
    s_add_u32 s67, s67, s33
    v_mfma_f32_32x32x16_bf16 v[72:87], v[136:139], v[148:151], v[72:87]
    ds_read_b64_tr_b16 v[166:167], v193 offset:6656
    ds_read_b64_tr_b16 v[168:169], v193 offset:14336
    ds_read_b64_tr_b16 v[170:171], v193 offset:14848
    s_add_u32 s67, s67, 12779520
    s_lshl_b32 s64, s57, 7
    s_add_u32 s64, s64, 12883968
    s_lshl_b32 s70, s31, 12
    s_add_u32 s70, s70, 40960
    v_mfma_f32_32x32x16_bf16 v[104:119], v[136:139], v[152:155], v[104:119]
    ds_read_b64_tr_b16 v[172:173], v193 offset:22528
    ds_read_b64_tr_b16 v[174:175], v193 offset:23040
    s_lshl_b32 s68, s56, 18
    s_lshl_b32 s33, s31, 16
    s_add_u32 s68, s68, s33
    s_add_u32 s68, s68, s90
    s_mov_b32 s69, 0
    v_mfma_f32_32x32x16_bf16 v[56:71], v[144:147], v[140:143], v[56:71]
    s_add_u32 s28, s28, 40960
    s_cmp_eq_u32 s28, 122880
    s_cselect_b32 s28, 0, s28
    v_mfma_f32_32x32x16_bf16 v[88:103], v[140:143], v[148:151], v[88:103]
    v_add_u32 v189, s28, v184
    v_add_u32 v190, s28, v185
    v_add_u32 v191, s28, v186
    v_add_u32 v192, s28, v187
    v_add_u32 v193, s28, v188
    s_add_u32 s30, s30, 1
    s_cmp_lt_u32 s30, 14
    v_mfma_f32_32x32x16_bf16 v[120:135], v[140:143], v[152:155], v[120:135]
    s_setprio 3
    s_waitcnt vmcnt(0) lgkmcnt(0)
    s_barrier
    v_mfma_f32_32x32x16_bf16 v[72:87], v[156:159], v[168:171], v[72:87]
    ds_read_b128 v[216:219], v189 offset:0
    ds_read_b64_tr_b16 v[136:137], v193 offset:8192
    ds_read_b64_tr_b16 v[138:139], v193 offset:8704
    ds_read_b128 v[224:227], v190 offset:0
    v_mfma_f32_32x32x16_bf16 v[88:103], v[160:163], v[168:171], v[88:103]
    ds_read_b64_tr_b16 v[140:141], v193 offset:10240
    ds_read_b64_tr_b16 v[142:143], v193 offset:10752
    ds_read_b128 v[232:235], v191 offset:0
    ds_read_b64_tr_b16 v[144:145], v193 offset:12288
    v_mfma_f32_32x32x16_bf16 v[104:119], v[156:159], v[172:175], v[104:119]
    ds_read_b64_tr_b16 v[146:147], v193 offset:12800
    ds_read_b128 v[240:243], v192 offset:0
    ds_read_b64_tr_b16 v[148:149], v193 offset:14336
    ds_read_b64_tr_b16 v[150:151], v193 offset:14848
    v_mfma_f32_32x32x16_bf16 v[120:135], v[160:163], v[172:175], v[120:135]
    ds_read_b128 v[220:223], v189 offset:4096
    ds_read_b128 v[228:231], v190 offset:4096
    ds_read_b128 v[236:239], v191 offset:4096
    ds_read_b128 v[244:247], v192 offset:4096
    v_mfma_f32_32x32x16_bf16 v[40:55], v[164:167], v[156:159], v[40:55]
    v_mfma_f32_32x32x16_bf16 v[56:71], v[164:167], v[160:163], v[56:71]
    s_waitcnt lgkmcnt(4)
    v_mfma_f32_32x32x16_bf16 v[72:87], v[216:219], v[136:139], v[72:87]
    ds_read_b64_tr_b16 v[156:157], v193 offset:16384
    ds_read_b64_tr_b16 v[158:159], v193 offset:16896
    v_mfma_f32_32x32x16_bf16 v[72:87], v[224:227], v[140:143], v[72:87]
    ds_read_b64_tr_b16 v[160:161], v193 offset:18432
    ds_read_b64_tr_b16 v[162:163], v193 offset:18944
    v_mfma_f32_32x32x16_bf16 v[72:87], v[232:235], v[144:147], v[72:87]
    ds_read_b64_tr_b16 v[164:165], v193 offset:20480
    ds_read_b64_tr_b16 v[166:167], v193 offset:20992
    v_mfma_f32_32x32x16_bf16 v[72:87], v[240:243], v[148:151], v[72:87]
    ds_read_b64_tr_b16 v[168:169], v193 offset:22528
    ds_read_b64_tr_b16 v[170:171], v193 offset:23040
    s_waitcnt lgkmcnt(8)
    v_mfma_f32_32x32x16_bf16 v[88:103], v[220:223], v[136:139], v[88:103]
    ds_read_b64_tr_b16 v[20:21], v193 offset:0
    ds_read_b64_tr_b16 v[22:23], v193 offset:512
    v_mfma_f32_32x32x16_bf16 v[88:103], v[228:231], v[140:143], v[88:103]
    ds_read_b64_tr_b16 v[24:25], v193 offset:2048
    ds_read_b64_tr_b16 v[26:27], v193 offset:2560
    v_mfma_f32_32x32x16_bf16 v[88:103], v[236:239], v[144:147], v[88:103]
    ds_read_b64_tr_b16 v[28:29], v193 offset:4096
    ds_read_b64_tr_b16 v[30:31], v193 offset:4608
    v_mfma_f32_32x32x16_bf16 v[88:103], v[244:247], v[148:151], v[88:103]
    ds_read_b64_tr_b16 v[32:33], v193 offset:6144
    ds_read_b64_tr_b16 v[34:35], v193 offset:6656
    s_waitcnt lgkmcnt(8)
    v_mfma_f32_32x32x16_bf16 v[104:119], v[216:219], v[156:159], v[104:119]
    v_mul_f32 v176, s42, v72
    v_mul_f32 v177, s42, v73
    v_mul_f32 v178, s42, v74
    v_mul_f32 v179, s42, v75
    v_exp_f32 v176, v176 clamp
    v_max_f32 v72, s44, v72
    v_exp_f32 v177, v177 clamp
    v_max_f32 v73, s44, v73
    v_exp_f32 v178, v178 clamp
    v_mfma_f32_32x32x16_bf16 v[104:119], v[224:227], v[160:163], v[104:119]
    v_max_f32 v74, s44, v74
    v_exp_f32 v179, v179 clamp
    v_max_f32 v75, s44, v75
    v_add_f32 v72, v72, v176
    v_add_f32 v73, v73, v177
    v_add_f32 v74, v74, v178
    v_add_f32 v75, v75, v179
    v_cvt_pk_bf16_f32 v136, v72, v73
    v_cvt_pk_bf16_f32 v137, v74, v75
    s_waitcnt lgkmcnt(0)
    s_mov_b64 exec, 1
    ds_add_u32 v36, v14 offset:20
    s_mov_b64 exec, -1
    v_mfma_f32_32x32x16_bf16 v[104:119], v[232:235], v[164:167], v[104:119]
    v_mul_f32 v180, s42, v76
    v_mul_f32 v181, s42, v77
    v_mul_f32 v182, s42, v78
    v_mul_f32 v183, s42, v79
    v_exp_f32 v180, v180 clamp
    v_max_f32 v76, s44, v76
    v_exp_f32 v181, v181 clamp
    v_max_f32 v77, s44, v77
    v_exp_f32 v182, v182 clamp
    v_mfma_f32_32x32x16_bf16 v[104:119], v[240:243], v[168:171], v[104:119]
    v_max_f32 v78, s44, v78
    v_exp_f32 v183, v183 clamp
    v_max_f32 v79, s44, v79
    v_add_f32 v76, v76, v180
    v_add_f32 v77, v77, v181
    v_add_f32 v78, v78, v182
    v_add_f32 v79, v79, v183
    v_cvt_pk_bf16_f32 v138, v76, v77
    v_cvt_pk_bf16_f32 v139, v78, v79
    v_mfma_f32_32x32x16_bf16 v[120:135], v[220:223], v[156:159], v[120:135]
    v_mul_f32 v176, s42, v80
    v_mul_f32 v177, s42, v81
    v_mul_f32 v178, s42, v82
    v_mul_f32 v179, s42, v83
    v_exp_f32 v176, v176 clamp
    v_max_f32 v80, s44, v80
    v_exp_f32 v177, v177 clamp
    v_max_f32 v81, s44, v81
    v_exp_f32 v178, v178 clamp
    v_mfma_f32_32x32x16_bf16 v[120:135], v[228:231], v[160:163], v[120:135]
    v_max_f32 v82, s44, v82
    v_exp_f32 v179, v179 clamp
    v_max_f32 v83, s44, v83
    v_add_f32 v80, v80, v176
    v_add_f32 v81, v81, v177
    v_add_f32 v82, v82, v178
    v_add_f32 v83, v83, v179
    v_cvt_pk_bf16_f32 v140, v80, v81
    v_cvt_pk_bf16_f32 v141, v82, v83
    ds_read_b32 v37, v36 offset:20
    v_mfma_f32_32x32x16_bf16 v[120:135], v[236:239], v[164:167], v[120:135]
    v_mul_f32 v180, s42, v84
    v_mul_f32 v181, s42, v85
    v_mul_f32 v182, s42, v86
    v_mul_f32 v183, s42, v87
    v_exp_f32 v180, v180 clamp
    v_max_f32 v84, s44, v84
    v_exp_f32 v181, v181 clamp
    v_max_f32 v85, s44, v85
    v_exp_f32 v182, v182 clamp
    v_mfma_f32_32x32x16_bf16 v[120:135], v[244:247], v[168:171], v[120:135]
    v_max_f32 v86, s44, v86
    v_exp_f32 v183, v183 clamp
    v_max_f32 v87, s44, v87
    v_add_f32 v84, v84, v180
    v_add_f32 v85, v85, v181
    v_add_f32 v86, v86, v182
    v_add_f32 v87, v87, v183
    v_cvt_pk_bf16_f32 v142, v84, v85
    v_cvt_pk_bf16_f32 v143, v86, v87
    s_waitcnt lgkmcnt(0)
    v_readfirstlane_b32 s45, v37
    s_nop 0
    s_cmp_ge_u32 s45, 4
    s_cbranch_scc1 L_r15
L_lwr:
    ds_read_b32 v37, v36 offset:20
    s_waitcnt lgkmcnt(0)
    v_readfirstlane_b32 s45, v37
    s_nop 0
    s_cmp_ge_u32 s45, 4
    s_cbranch_scc1 L_lor
    s_sleep 1
    s_branch L_lwr
L_lor:
L_r15:
    v_cvt_pk_bf16_f32 v196, v104, v105
    v_cvt_pk_bf16_f32 v197, v106, v107
    v_cvt_pk_bf16_f32 v198, v108, v109
    v_cvt_pk_bf16_f32 v199, v110, v111
    v_cvt_pk_bf16_f32 v200, v112, v113
    v_cvt_pk_bf16_f32 v201, v114, v115
    v_cvt_pk_bf16_f32 v202, v116, v117
    v_cvt_pk_bf16_f32 v203, v118, v119
    v_mfma_f32_32x32x16_bf16 v[104:119], v[212:215], v[136:139], 0
    s_add_u32 m0, s62, 0
    s_add_u32 s43, s90, 0
    buffer_load_dwordx4 v12, s[80:83], s43 offen offset:0 lds
    v_mul_f32 v176, s42, v88
    v_mul_f32 v177, s42, v89
    v_mul_f32 v178, s42, v90
    v_mul_f32 v179, s42, v91
    v_exp_f32 v176, v176 clamp
    s_add_u32 s43, s90, 15360
    buffer_load_dwordx4 v12, s[80:83], s43 offen offset:1024 lds
    v_max_f32 v88, s44, v88
    v_exp_f32 v177, v177 clamp
    v_max_f32 v89, s44, v89
    v_exp_f32 v178, v178 clamp
    v_mfma_f32_32x32x16_bf16 v[104:119], v[212:215], v[140:143], v[104:119]
    s_add_u32 s43, s90, 30720
    buffer_load_dwordx4 v12, s[80:83], s43 offen offset:2048 lds
    v_max_f32 v90, s44, v90
    v_exp_f32 v179, v179 clamp
    v_max_f32 v91, s44, v91
    v_add_f32 v88, v88, v176
    v_add_f32 v89, v89, v177
    s_add_u32 s43, s90, 46080
    buffer_load_dwordx4 v12, s[80:83], s43 offen offset:3072 lds
    v_add_f32 v90, v90, v178
    v_add_f32 v91, v91, v179
    v_cvt_pk_bf16_f32 v144, v88, v89
    v_cvt_pk_bf16_f32 v145, v90, v91
    v_mfma_f32_32x32x16_bf16 v[72:87], v[136:139], v[196:199], 0
    s_add_u32 m0, s62, 16384
    s_add_u32 s43, s90, 262144
    buffer_load_dwordx4 v12, s[80:83], s43 offen offset:0 lds
    v_mul_f32 v180, s42, v92
    v_mul_f32 v181, s42, v93
    v_mul_f32 v182, s42, v94
    v_mul_f32 v183, s42, v95
    v_exp_f32 v180, v180 clamp
    s_add_u32 s43, s90, 277504
    buffer_load_dwordx4 v12, s[80:83], s43 offen offset:1024 lds
    v_max_f32 v92, s44, v92
    v_exp_f32 v181, v181 clamp
    v_max_f32 v93, s44, v93
    v_exp_f32 v182, v182 clamp
    v_mfma_f32_32x32x16_bf16 v[72:87], v[140:143], v[200:203], v[72:87]
    s_add_u32 s43, s90, 292864
    buffer_load_dwordx4 v12, s[80:83], s43 offen offset:2048 lds
    v_max_f32 v94, s44, v94
    v_exp_f32 v183, v183 clamp
    v_max_f32 v95, s44, v95
    v_add_f32 v92, v92, v180
    v_add_f32 v93, v93, v181
    s_add_u32 s43, s90, 308224
    buffer_load_dwordx4 v12, s[80:83], s43 offen offset:3072 lds
    v_add_f32 v94, v94, v182
    v_add_f32 v95, v95, v183
    v_cvt_pk_bf16_f32 v146, v92, v93
    v_cvt_pk_bf16_f32 v147, v94, v95
    v_cvt_pk_bf16_f32 v204, v120, v121
    v_cvt_pk_bf16_f32 v205, v122, v123
    v_cvt_pk_bf16_f32 v206, v124, v125
    v_cvt_pk_bf16_f32 v207, v126, v127
    v_cvt_pk_bf16_f32 v208, v128, v129
    v_cvt_pk_bf16_f32 v209, v130, v131
    v_cvt_pk_bf16_f32 v210, v132, v133
    v_cvt_pk_bf16_f32 v211, v134, v135
    v_mfma_f32_32x32x16_bf16 v[104:119], v[212:215], v[144:147], v[104:119]
    v_mul_f32 v176, s42, v96
    v_mul_f32 v177, s42, v97
    v_mul_f32 v178, s42, v98
    v_mul_f32 v179, s42, v99
    v_exp_f32 v176, v176 clamp
    v_max_f32 v96, s44, v96
    v_exp_f32 v177, v177 clamp
    v_max_f32 v97, s44, v97
    v_exp_f32 v178, v178 clamp
    v_max_f32 v98, s44, v98
    v_exp_f32 v179, v179 clamp
    v_max_f32 v99, s44, v99
    v_add_f32 v96, v96, v176
    v_add_f32 v97, v97, v177
    v_add_f32 v98, v98, v178
    v_add_f32 v99, v99, v179
    v_cvt_pk_bf16_f32 v148, v96, v97
    v_cvt_pk_bf16_f32 v149, v98, v99
    v_mfma_f32_32x32x16_bf16 v[72:87], v[144:147], v[204:207], v[72:87]
    v_mul_f32 v180, s42, v100
    v_mul_f32 v181, s42, v101
    v_mul_f32 v182, s42, v102
    v_mul_f32 v183, s42, v103
    v_exp_f32 v180, v180 clamp
    v_max_f32 v100, s44, v100
    v_exp_f32 v181, v181 clamp
    v_max_f32 v101, s44, v101
    v_exp_f32 v182, v182 clamp
    v_max_f32 v102, s44, v102
    v_exp_f32 v183, v183 clamp
    v_max_f32 v103, s44, v103
    v_add_f32 v100, v100, v180
    v_add_f32 v101, v101, v181
    v_add_f32 v102, v102, v182
    v_add_f32 v103, v103, v183
    v_cvt_pk_bf16_f32 v150, v100, v101
    v_cvt_pk_bf16_f32 v151, v102, v103
    s_nop 1
    v_mfma_f32_32x32x16_bf16 v[72:87], v[148:151], v[208:211], v[72:87]
    v_mfma_f32_32x32x16_bf16 v[104:119], v[212:215], v[148:151], v[104:119]
    s_waitcnt lgkmcnt(0)
    s_nop 9
    ds_write_b128 v3, v[72:75] offset:0
    ds_write_b128 v3, v[76:79] offset:1024
    ds_write_b128 v3, v[80:83] offset:2048
    ds_write_b128 v3, v[84:87] offset:3072
    ds_write_b32 v3, v104 offset:4096
    v_mfma_f32_32x32x16_bf16 v[40:55], v[20:23], v[216:219], v[40:55]
    v_mfma_f32_32x32x16_bf16 v[40:55], v[24:27], v[224:227], v[40:55]
    v_mfma_f32_32x32x16_bf16 v[40:55], v[28:31], v[232:235], v[40:55]
    s_waitcnt lgkmcnt(0)
    s_mov_b64 exec, 1
    ds_add_u32 v8, v7 offset:0
    s_mov_b64 exec, -1
    ds_read_b32 v9, v8
    v_mfma_f32_32x32x16_bf16 v[40:55], v[32:35], v[240:243], v[40:55]
    v_mfma_f32_32x32x16_bf16 v[56:71], v[20:23], v[220:223], v[56:71]
L_pw:
    s_waitcnt lgkmcnt(0)
    v_readfirstlane_b32 s45, v9
    s_nop 0
    s_cmp_ge_u32 s45, 4
    s_cbranch_scc1 L_pwo
    ds_read_b32 v9, v8
    s_branch L_pw
L_pwo:
    ds_read_b32 v72, v5 offset:0
    ds_read_b32 v80, v5 offset:5120
    ds_read_b32 v73, v5 offset:256
    ds_read_b32 v81, v5 offset:5376
    v_mfma_f32_32x32x16_bf16 v[56:71], v[24:27], v[228:231], v[56:71]
    ds_read_b32 v74, v5 offset:512
    ds_read_b32 v82, v5 offset:5632
    ds_read_b32 v75, v5 offset:768
    ds_read_b32 v83, v5 offset:5888
    v_mfma_f32_32x32x16_bf16 v[56:71], v[28:31], v[236:239], v[56:71]
    ds_read_b32 v76, v5 offset:1024
    ds_read_b32 v84, v5 offset:6144
    ds_read_b32 v77, v5 offset:1280
    ds_read_b32 v85, v5 offset:6400
    v_mfma_f32_32x32x16_bf16 v[56:71], v[32:35], v[244:247], v[56:71]
    s_waitcnt lgkmcnt(4)
    ds_read_b32 v78, v5 offset:1536
    ds_read_b32 v86, v5 offset:6656
    ds_read_b32 v79, v5 offset:1792
    ds_read_b32 v87, v5 offset:6912
    ds_read_b32 v88, v4 offset:4096
    ds_read_b32 v89, v4 offset:9216
    v_mov_b32 v6, 163584
    v_add_f32 v72, v72, v80
    v_add_f32 v73, v73, v81
    v_add_f32 v74, v74, v82
    v_add_f32 v75, v75, v83
    buffer_atomic_add_f32 v72, v11, s[16:19], s54 offen offset:0
    buffer_atomic_add_f32 v73, v11, s[16:19], s54 offen offset:256
    buffer_atomic_add_f32 v74, v11, s[16:19], s54 offen offset:512
    buffer_atomic_add_f32 v75, v11, s[16:19], s54 offen offset:768
    s_waitcnt lgkmcnt(0)
    v_add_f32 v76, v76, v84
    v_add_f32 v77, v77, v85
    v_add_f32 v78, v78, v86
    v_add_f32 v79, v79, v87
    buffer_atomic_add_f32 v76, v11, s[16:19], s54 offen offset:1024
    buffer_atomic_add_f32 v77, v11, s[16:19], s54 offen offset:1280
    buffer_atomic_add_f32 v78, v11, s[16:19], s54 offen offset:1536
    buffer_atomic_add_f32 v79, v11, s[16:19], s54 offen offset:1792
    s_mov_b64 exec, 1
    ds_add_u32 v6, v7 offset:4
    s_mov_b64 exec, -1
    v_add_f32 v88, v88, v89
    s_cmp_lg_u32 s47, 0
    s_cbranch_scc1 L_nz
    s_mov_b32 exec_hi, 0
    buffer_atomic_add_f32 v88, v11, s[16:19], s52 offen
    s_mov_b64 exec, -1
L_nz:
    s_setprio 3
    s_mov_b32 s12, s72
    s_mov_b32 s13, s73
    s_mov_b32 s14, 0x800
    s_mov_b32 s15, 0x00020000
    v_mul_f32 v176, s42, v40
    v_mul_f32 v177, s42, v41
    v_mul_f32 v178, s42, v42
    v_mul_f32 v179, s42, v43
    v_exp_f32 v176, v176 clamp
    v_max_f32 v40, s44, v40
    v_exp_f32 v177, v177 clamp
    v_max_f32 v41, s44, v41
    v_exp_f32 v178, v178 clamp
    v_max_f32 v42, s44, v42
    v_exp_f32 v179, v179 clamp
    v_max_f32 v43, s44, v43
    v_add_f32 v40, v40, v176
    v_add_f32 v41, v41, v177
    v_add_f32 v42, v42, v178
    v_add_f32 v43, v43, v179
    v_cvt_pk_bf16_f32 v20, v40, v41
    v_cvt_pk_bf16_f32 v21, v42, v43
    v_mul_f32 v180, s42, v44
    v_mul_f32 v181, s42, v45
    v_mul_f32 v182, s42, v46
    v_mul_f32 v183, s42, v47
    v_exp_f32 v180, v180 clamp
    v_max_f32 v44, s44, v44
    v_exp_f32 v181, v181 clamp
    v_max_f32 v45, s44, v45
    v_exp_f32 v182, v182 clamp
    v_max_f32 v46, s44, v46
    v_exp_f32 v183, v183 clamp
    v_max_f32 v47, s44, v47
    v_add_f32 v44, v44, v180
    v_add_f32 v45, v45, v181
    v_add_f32 v46, v46, v182
    v_add_f32 v47, v47, v183
    v_cvt_pk_bf16_f32 v22, v44, v45
    v_cvt_pk_bf16_f32 v23, v46, v47
    v_mul_f32 v176, s42, v48
    v_mul_f32 v177, s42, v49
    v_mul_f32 v178, s42, v50
    v_mul_f32 v179, s42, v51
    v_exp_f32 v176, v176 clamp
    v_max_f32 v48, s44, v48
    v_exp_f32 v177, v177 clamp
    v_max_f32 v49, s44, v49
    v_exp_f32 v178, v178 clamp
    v_max_f32 v50, s44, v50
    v_exp_f32 v179, v179 clamp
    v_max_f32 v51, s44, v51
    v_add_f32 v48, v48, v176
    v_add_f32 v49, v49, v177
    v_add_f32 v50, v50, v178
    v_add_f32 v51, v51, v179
    v_cvt_pk_bf16_f32 v24, v48, v49
    v_cvt_pk_bf16_f32 v25, v50, v51
    v_mul_f32 v180, s42, v52
    v_mul_f32 v181, s42, v53
    v_mul_f32 v182, s42, v54
    v_mul_f32 v183, s42, v55
    v_exp_f32 v180, v180 clamp
    v_max_f32 v52, s44, v52
    v_exp_f32 v181, v181 clamp
    v_max_f32 v53, s44, v53
    v_exp_f32 v182, v182 clamp
    v_max_f32 v54, s44, v54
    v_exp_f32 v183, v183 clamp
    v_max_f32 v55, s44, v55
    v_add_f32 v52, v52, v180
    v_add_f32 v53, v53, v181
    v_add_f32 v54, v54, v182
    v_add_f32 v55, v55, v183
    v_cvt_pk_bf16_f32 v26, v52, v53
    v_cvt_pk_bf16_f32 v27, v54, v55
    v_mul_f32 v176, s42, v56
    v_mul_f32 v177, s42, v57
    v_mul_f32 v178, s42, v58
    v_mul_f32 v179, s42, v59
    v_exp_f32 v176, v176 clamp
    v_max_f32 v56, s44, v56
    v_exp_f32 v177, v177 clamp
    v_max_f32 v57, s44, v57
    v_exp_f32 v178, v178 clamp
    v_max_f32 v58, s44, v58
    v_exp_f32 v179, v179 clamp
    v_max_f32 v59, s44, v59
    v_add_f32 v56, v56, v176
    v_add_f32 v57, v57, v177
    v_add_f32 v58, v58, v178
    v_add_f32 v59, v59, v179
    v_cvt_pk_bf16_f32 v28, v56, v57
    v_cvt_pk_bf16_f32 v29, v58, v59
    v_mul_f32 v180, s42, v60
    v_mul_f32 v181, s42, v61
    v_mul_f32 v182, s42, v62
    v_mul_f32 v183, s42, v63
    v_exp_f32 v180, v180 clamp
    v_max_f32 v60, s44, v60
    v_exp_f32 v181, v181 clamp
    v_max_f32 v61, s44, v61
    v_exp_f32 v182, v182 clamp
    v_max_f32 v62, s44, v62
    v_exp_f32 v183, v183 clamp
    v_max_f32 v63, s44, v63
    v_add_f32 v60, v60, v180
    v_add_f32 v61, v61, v181
    v_add_f32 v62, v62, v182
    v_add_f32 v63, v63, v183
    v_cvt_pk_bf16_f32 v30, v60, v61
    v_cvt_pk_bf16_f32 v31, v62, v63
    v_mul_f32 v176, s42, v64
    v_mul_f32 v177, s42, v65
    v_mul_f32 v178, s42, v66
    v_mul_f32 v179, s42, v67
    v_exp_f32 v176, v176 clamp
    v_max_f32 v64, s44, v64
    v_exp_f32 v177, v177 clamp
    v_max_f32 v65, s44, v65
    v_exp_f32 v178, v178 clamp
    v_max_f32 v66, s44, v66
    v_exp_f32 v179, v179 clamp
    v_max_f32 v67, s44, v67
    v_add_f32 v64, v64, v176
    v_add_f32 v65, v65, v177
    v_add_f32 v66, v66, v178
    v_add_f32 v67, v67, v179
    v_cvt_pk_bf16_f32 v32, v64, v65
    v_cvt_pk_bf16_f32 v33, v66, v67
    v_mul_f32 v180, s42, v68
    v_mul_f32 v181, s42, v69
    v_mul_f32 v182, s42, v70
    v_mul_f32 v183, s42, v71
    v_exp_f32 v180, v180 clamp
    v_max_f32 v68, s44, v68
    v_exp_f32 v181, v181 clamp
    v_max_f32 v69, s44, v69
    v_exp_f32 v182, v182 clamp
    v_max_f32 v70, s44, v70
    v_exp_f32 v183, v183 clamp
    v_max_f32 v71, s44, v71
    v_add_f32 v68, v68, v180
    v_add_f32 v69, v69, v181
    v_add_f32 v70, v70, v182
    v_add_f32 v71, v71, v183
    v_cvt_pk_bf16_f32 v34, v68, v69
    v_cvt_pk_bf16_f32 v35, v70, v71
    s_waitcnt vmcnt(0)
    s_mov_b64 exec, 15
    buffer_atomic_add v14, v13, s[16:19], s60 offen
    s_mov_b64 exec, -1
    buffer_load_dwordx4 v[232:235], v10, s[12:15], 0 offen offset:0
    buffer_load_dwordx4 v[236:239], v10, s[12:15], 0 offen offset:1024
    buffer_load_dwordx4 v[216:219], v10, s[8:11], s85 offen offset:0
    buffer_load_dwordx4 v[220:223], v10, s[8:11], s85 offen offset:2048
    buffer_load_dwordx4 v[224:227], v10, s[8:11], s85 offen offset:1024
    buffer_load_dwordx4 v[228:231], v10, s[8:11], s85 offen offset:3072
L_lwh:
    ds_read_b32 v37, v36 offset:4
    s_waitcnt lgkmcnt(0)
    v_readfirstlane_b32 s55, v37
    s_nop 0
    s_cmp_ge_u32 s55, 4
    s_cbranch_scc1 L_loh
    s_sleep 1
    s_branch L_lwh
L_loh:
    s_add_u32 m0, s62, 59392
    s_add_u32 s43, s90, 524288
    buffer_load_dwordx4 v12, s[80:83], s43 offen offset:0 lds
    s_add_u32 s43, s90, 539648
    buffer_load_dwordx4 v12, s[80:83], s43 offen offset:1024 lds
    s_add_u32 s43, s90, 555008
    buffer_load_dwordx4 v12, s[80:83], s43 offen offset:2048 lds
    s_add_u32 s43, s90, 570368
    buffer_load_dwordx4 v12, s[80:83], s43 offen offset:3072 lds
    s_waitcnt vmcnt(4)
    v_mov_b32 v246, 0
    v_mov_b32 v247, 0
    v_lshlrev_b32 v240, 16, v232
    v_and_b32 v241, 0xffff0000, v232
    v_lshlrev_b32 v242, 16, v216
    v_and_b32 v243, 0xffff0000, v216
    v_mul_f32 v242, v242, v240
    v_mul_f32 v243, v243, v241
    v_lshlrev_b32 v244, 16, v220
    v_and_b32 v245, 0xffff0000, v220
    v_mul_f32 v244, v244, v240
    v_mul_f32 v245, v245, v241
    v_cvt_pk_bf16_f32 v242, v242, v243
    v_cvt_pk_bf16_f32 v244, v244, v245
    v_and_b32 v243, 0xffff0000, v242
    v_lshlrev_b32 v242, 16, v242
    v_add_f32 v246, v246, v243
    v_add_f32 v246, v246, v242
    v_mov_b32 v38, 0
    s_mov_b64 exec, 1
    buffer_atomic_add v38, v15, s[16:19], s59 offen sc0
    s_mov_b64 exec, -1
    v_and_b32 v245, 0xffff0000, v244
    v_lshlrev_b32 v244, 16, v244
    v_add_f32 v247, v247, v245
    v_add_f32 v247, v247, v244
    v_lshlrev_b32 v240, 16, v233
    v_and_b32 v241, 0xffff0000, v233
    v_lshlrev_b32 v242, 16, v217
    v_and_b32 v243, 0xffff0000, v217
    v_mul_f32 v242, v242, v240
    v_mul_f32 v243, v243, v241
    v_lshlrev_b32 v244, 16, v221
    v_and_b32 v245, 0xffff0000, v221
    v_mul_f32 v244, v244, v240
    v_mul_f32 v245, v245, v241
    v_cvt_pk_bf16_f32 v242, v242, v243
    v_cvt_pk_bf16_f32 v244, v244, v245
    v_and_b32 v243, 0xffff0000, v242
    v_lshlrev_b32 v242, 16, v242
    v_add_f32 v246, v246, v243
    v_add_f32 v246, v246, v242
    v_and_b32 v245, 0xffff0000, v244
    v_lshlrev_b32 v244, 16, v244
    v_add_f32 v247, v247, v245
    v_add_f32 v247, v247, v244
    v_lshlrev_b32 v240, 16, v234
    v_and_b32 v241, 0xffff0000, v234
    v_lshlrev_b32 v242, 16, v218
    v_and_b32 v243, 0xffff0000, v218
    v_mul_f32 v242, v242, v240
    v_mul_f32 v243, v243, v241
    v_lshlrev_b32 v244, 16, v222
    v_and_b32 v245, 0xffff0000, v222
    v_mul_f32 v244, v244, v240
    v_mul_f32 v245, v245, v241
    v_cvt_pk_bf16_f32 v242, v242, v243
    v_cvt_pk_bf16_f32 v244, v244, v245
    v_and_b32 v243, 0xffff0000, v242
    v_lshlrev_b32 v242, 16, v242
    v_add_f32 v246, v246, v243
    v_add_f32 v246, v246, v242
    v_and_b32 v245, 0xffff0000, v244
    v_lshlrev_b32 v244, 16, v244
    v_add_f32 v247, v247, v245
    v_add_f32 v247, v247, v244
    v_lshlrev_b32 v240, 16, v235
    v_and_b32 v241, 0xffff0000, v235
    v_lshlrev_b32 v242, 16, v219
    v_and_b32 v243, 0xffff0000, v219
    v_mul_f32 v242, v242, v240
    v_mul_f32 v243, v243, v241
    v_lshlrev_b32 v244, 16, v223
    v_and_b32 v245, 0xffff0000, v223
    v_mul_f32 v244, v244, v240
    v_mul_f32 v245, v245, v241
    v_cvt_pk_bf16_f32 v242, v242, v243
    v_cvt_pk_bf16_f32 v244, v244, v245
    v_and_b32 v243, 0xffff0000, v242
    v_lshlrev_b32 v242, 16, v242
    v_add_f32 v246, v246, v243
    v_add_f32 v246, v246, v242
    v_and_b32 v245, 0xffff0000, v244
    v_lshlrev_b32 v244, 16, v244
    v_add_f32 v247, v247, v245
    v_add_f32 v247, v247, v244
    v_lshlrev_b32 v240, 16, v236
    v_and_b32 v241, 0xffff0000, v236
    v_lshlrev_b32 v242, 16, v224
    v_and_b32 v243, 0xffff0000, v224
    v_mul_f32 v242, v242, v240
    v_mul_f32 v243, v243, v241
    v_lshlrev_b32 v244, 16, v228
    v_and_b32 v245, 0xffff0000, v228
    v_mul_f32 v244, v244, v240
    v_mul_f32 v245, v245, v241
    v_cvt_pk_bf16_f32 v242, v242, v243
    v_cvt_pk_bf16_f32 v244, v244, v245
    v_mov_b32 v39, 0
    s_mov_b64 exec, 1
    buffer_atomic_add v39, v15, s[16:19], s59 offen sc0
    s_mov_b64 exec, -1
    v_and_b32 v243, 0xffff0000, v242
    v_lshlrev_b32 v242, 16, v242
    v_add_f32 v246, v246, v243
    v_add_f32 v246, v246, v242
    v_and_b32 v245, 0xffff0000, v244
    v_lshlrev_b32 v244, 16, v244
    v_add_f32 v247, v247, v245
    v_add_f32 v247, v247, v244
    v_lshlrev_b32 v240, 16, v237
    v_and_b32 v241, 0xffff0000, v237
    v_lshlrev_b32 v242, 16, v225
    v_and_b32 v243, 0xffff0000, v225
    v_mul_f32 v242, v242, v240
    v_mul_f32 v243, v243, v241
    v_lshlrev_b32 v244, 16, v229
    v_and_b32 v245, 0xffff0000, v229
    v_mul_f32 v244, v244, v240
    v_mul_f32 v245, v245, v241
    v_cvt_pk_bf16_f32 v242, v242, v243
    v_cvt_pk_bf16_f32 v244, v244, v245
    v_and_b32 v243, 0xffff0000, v242
    v_lshlrev_b32 v242, 16, v242
    v_add_f32 v246, v246, v243
    v_add_f32 v246, v246, v242
    v_and_b32 v245, 0xffff0000, v244
    v_lshlrev_b32 v244, 16, v244
    v_add_f32 v247, v247, v245
    v_add_f32 v247, v247, v244
    v_lshlrev_b32 v240, 16, v238
    v_and_b32 v241, 0xffff0000, v238
    v_lshlrev_b32 v242, 16, v226
    v_and_b32 v243, 0xffff0000, v226
    v_mul_f32 v242, v242, v240
    v_mul_f32 v243, v243, v241
    v_lshlrev_b32 v244, 16, v230
    v_and_b32 v245, 0xffff0000, v230
    v_mul_f32 v244, v244, v240
    v_mul_f32 v245, v245, v241
    v_cvt_pk_bf16_f32 v242, v242, v243
    v_cvt_pk_bf16_f32 v244, v244, v245
    v_and_b32 v243, 0xffff0000, v242
    v_lshlrev_b32 v242, 16, v242
    v_add_f32 v246, v246, v243
    v_add_f32 v246, v246, v242
    v_and_b32 v245, 0xffff0000, v244
    v_lshlrev_b32 v244, 16, v244
    v_add_f32 v247, v247, v245
    v_add_f32 v247, v247, v244
    v_lshlrev_b32 v240, 16, v239
    v_and_b32 v241, 0xffff0000, v239
    v_lshlrev_b32 v242, 16, v227
    v_and_b32 v243, 0xffff0000, v227
    v_mul_f32 v242, v242, v240
    v_mul_f32 v243, v243, v241
    v_lshlrev_b32 v244, 16, v231
    v_and_b32 v245, 0xffff0000, v231
    v_mul_f32 v244, v244, v240
    v_mul_f32 v245, v245, v241
    v_cvt_pk_bf16_f32 v242, v242, v243
    v_cvt_pk_bf16_f32 v244, v244, v245
    v_and_b32 v243, 0xffff0000, v242
    v_lshlrev_b32 v242, 16, v242
    v_add_f32 v246, v246, v243
    v_add_f32 v246, v246, v242
    v_and_b32 v245, 0xffff0000, v244
    v_lshlrev_b32 v244, 16, v244
    v_add_f32 v247, v247, v245
    v_add_f32 v247, v247, v244
    v_add_f32_dpp v246, v246, v246 quad_perm:[1,0,3,2] row_mask:0xf bank_mask:0xf
    s_nop 0
    v_add_f32_dpp v247, v247, v247 quad_perm:[1,0,3,2] row_mask:0xf bank_mask:0xf
    v_add_f32_dpp v246, v246, v246 quad_perm:[2,3,0,1] row_mask:0xf bank_mask:0xf
    s_nop 0
    v_add_f32_dpp v247, v247, v247 quad_perm:[2,3,0,1] row_mask:0xf bank_mask:0xf
    v_add_f32_dpp v246, v246, v246 row_half_mirror row_mask:0xf bank_mask:0xf
    s_nop 0
    v_add_f32_dpp v247, v247, v247 row_half_mirror row_mask:0xf bank_mask:0xf
    v_add_f32_dpp v246, v246, v246 row_mirror row_mask:0xf bank_mask:0xf
    v_mov_b32 v9, 0
    s_mov_b64 exec, 1
    buffer_atomic_add v9, v15, s[16:19], s59 offen sc0
    s_mov_b64 exec, -1
    v_add_f32_dpp v247, v247, v247 row_mirror row_mask:0xf bank_mask:0xf
    v_add_f32_dpp v246, v246, v246 row_bcast:15 row_mask:0xa bank_mask:0xf
    s_nop 0
    v_add_f32_dpp v247, v247, v247 row_bcast:15 row_mask:0xa bank_mask:0xf
    v_add_f32_dpp v246, v246, v246 row_bcast:31 row_mask:0xc bank_mask:0xf
    s_nop 0
    v_add_f32_dpp v247, v247, v247 row_bcast:31 row_mask:0xc bank_mask:0xf
    v_cvt_pk_bf16_f32 v246, v246, v247
    v_and_b32 v247, 0xffff0000, v246
    v_lshlrev_b32 v246, 16, v246
    v_mul_f32 v246, 0xbfb8aa3b, v246
    v_mul_f32 v247, 0xbfb8aa3b, v247
    v_exp_f32 v246, v246
    v_exp_f32 v247, v247
    v_add_f32 v246, 1.0, v246
    v_add_f32 v247, 1.0, v247
    v_rcp_f32 v246, v246
    v_rcp_f32 v247, v247
    s_nop 0
    v_cvt_pk_bf16_f32 v246, v246, v247
    v_and_b32 v247, 0xffff0000, v246
    v_lshlrev_b32 v246, 16, v246
    s_mov_b32 exec_lo, 0
    s_mov_b32 exec_hi, 0x80000000
    buffer_store_dwordx2 v[246:247], v15, s[16:19], s84 offen sc1
    s_mov_b64 exec, -1
    s_mov_b32 s55, 0
L_ppk:
    s_waitcnt vmcnt(2)
    v_readfirstlane_b32 s54, v38
    s_nop 0
    s_cmp_ge_u32 s54, 32
    s_cbranch_scc1 L_ppdk
    v_mov_b32 v38, 0
    s_mov_b64 exec, 1
    buffer_atomic_add v38, v15, s[16:19], s59 offen sc0
    s_mov_b64 exec, -1
    s_waitcnt vmcnt(2)
    v_readfirstlane_b32 s54, v39
    s_nop 0
    s_cmp_ge_u32 s54, 32
    s_cbranch_scc1 L_ppdk
    v_mov_b32 v39, 0
    s_mov_b64 exec, 1
    buffer_atomic_add v39, v15, s[16:19], s59 offen sc0
    s_mov_b64 exec, -1
    s_waitcnt vmcnt(2)
    v_readfirstlane_b32 s54, v9
    s_nop 0
    s_cmp_ge_u32 s54, 32
    s_cbranch_scc1 L_ppdk
    v_mov_b32 v9, 0
    s_mov_b64 exec, 1
    buffer_atomic_add v9, v15, s[16:19], s59 offen sc0
    s_mov_b64 exec, -1
    s_add_u32 s55, s55, 1
    s_cmp_lt_u32 s55, 0x20000
    s_cbranch_scc1 L_ppk
L_ppdk:
    buffer_load_dwordx4 v[76:79], v16, s[16:19], s91 offen offset:0 sc1
    buffer_load_dwordx4 v[80:83], v16, s[16:19], s91 offen offset:32 sc1
    buffer_load_dwordx4 v[84:87], v16, s[16:19], s91 offen offset:64 sc1
    buffer_load_dwordx4 v[88:91], v16, s[16:19], s91 offen offset:96 sc1
    buffer_load_dwordx4 v[60:63], v10, s[16:19], s92 offen offset:0 sc1
    buffer_load_dwordx4 v[64:67], v10, s[16:19], s92 offen offset:1024 sc1
    buffer_load_dwordx4 v[68:71], v10, s[16:19], s92 offen offset:2048 sc1
    buffer_load_dwordx4 v[72:75], v10, s[16:19], s92 offen offset:3072 sc1
    s_waitcnt vmcnt(4)
    v_cvt_pk_bf16_f32 v100, v76, v77
    v_cvt_pk_bf16_f32 v101, v78, v79
    v_cvt_pk_bf16_f32 v102, v80, v81
    v_cvt_pk_bf16_f32 v103, v82, v83
    v_cvt_pk_bf16_f32 v104, v84, v85
    v_cvt_pk_bf16_f32 v105, v86, v87
    v_cvt_pk_bf16_f32 v106, v88, v89
    v_cvt_pk_bf16_f32 v107, v90, v91
    v_mfma_f32_32x32x16_bf16 v[140:155], v[100:103], v[20:23], 0
    s_nop 0
    v_mfma_f32_32x32x16_bf16 v[140:155], v[104:107], v[24:27], v[140:155]
    v_mfma_f32_32x32x16_bf16 v[156:171], v[100:103], v[28:31], 0
    v_mfma_f32_32x32x16_bf16 v[156:171], v[104:107], v[32:35], v[156:171]
    s_waitcnt vmcnt(0)
    v_cvt_pk_bf16_f32 v92, v60, v61
    v_cvt_pk_bf16_f32 v93, v62, v63
    v_cvt_pk_bf16_f32 v94, v64, v65
    v_cvt_pk_bf16_f32 v95, v66, v67
    v_cvt_pk_bf16_f32 v96, v68, v69
    v_cvt_pk_bf16_f32 v97, v70, v71
    v_cvt_pk_bf16_f32 v98, v72, v73
    v_cvt_pk_bf16_f32 v99, v74, v75
    v_mfma_f32_32x32x16_bf16 v[108:123], v[92:95], v[20:23], 0
    s_nop 0
    v_mfma_f32_32x32x16_bf16 v[108:123], v[96:99], v[24:27], v[108:123]
    v_mfma_f32_32x32x16_bf16 v[124:139], v[92:95], v[28:31], 0
    v_mfma_f32_32x32x16_bf16 v[124:139], v[96:99], v[32:35], v[124:139]
    v_add_f32 v4, 0x358637bd, v140
    v_rcp_f32 v4, v4
    v_add_f32 v5, 0x358637bd, v156
    v_rcp_f32 v5, v5
    s_nop 5
    v_mul_f32 v108, v108, v4
    v_mul_f32 v109, v109, v4
    v_mul_f32 v110, v110, v4
    v_mul_f32 v111, v111, v4
    v_mul_f32 v112, v112, v4
    v_mul_f32 v113, v113, v4
    v_mul_f32 v114, v114, v4
    v_mul_f32 v115, v115, v4
    v_cvt_pk_bf16_f32 v20, v108, v109
    v_cvt_pk_bf16_f32 v21, v110, v111
    v_cvt_pk_bf16_f32 v22, v112, v113
    v_cvt_pk_bf16_f32 v23, v114, v115
    buffer_store_dwordx4 v[20:23], v10, s[16:19], s86 offen offset:0 sc1
    v_mul_f32 v116, v116, v4
    v_mul_f32 v117, v117, v4
    v_mul_f32 v118, v118, v4
    v_mul_f32 v119, v119, v4
    v_mul_f32 v120, v120, v4
    v_mul_f32 v121, v121, v4
    v_mul_f32 v122, v122, v4
    v_mul_f32 v123, v123, v4
    v_cvt_pk_bf16_f32 v24, v116, v117
    v_cvt_pk_bf16_f32 v25, v118, v119
    v_cvt_pk_bf16_f32 v26, v120, v121
    v_cvt_pk_bf16_f32 v27, v122, v123
    buffer_store_dwordx4 v[24:27], v10, s[16:19], s86 offen offset:1024 sc1
    v_mul_f32 v124, v124, v5
    v_mul_f32 v125, v125, v5
    v_mul_f32 v126, v126, v5
    v_mul_f32 v127, v127, v5
    v_mul_f32 v128, v128, v5
    v_mul_f32 v129, v129, v5
    v_mul_f32 v130, v130, v5
    v_mul_f32 v131, v131, v5
    v_cvt_pk_bf16_f32 v28, v124, v125
    v_cvt_pk_bf16_f32 v29, v126, v127
    v_cvt_pk_bf16_f32 v30, v128, v129
    v_cvt_pk_bf16_f32 v31, v130, v131
    buffer_store_dwordx4 v[28:31], v10, s[16:19], s87 offen offset:0 sc1
    v_mul_f32 v132, v132, v5
    v_mul_f32 v133, v133, v5
    v_mul_f32 v134, v134, v5
    v_mul_f32 v135, v135, v5
    v_mul_f32 v136, v136, v5
    v_mul_f32 v137, v137, v5
    v_mul_f32 v138, v138, v5
    v_mul_f32 v139, v139, v5
    v_cvt_pk_bf16_f32 v32, v132, v133
    v_cvt_pk_bf16_f32 v33, v134, v135
    v_cvt_pk_bf16_f32 v34, v136, v137
    v_cvt_pk_bf16_f32 v35, v138, v139
    buffer_store_dwordx4 v[32:35], v10, s[16:19], s87 offen offset:1024 sc1
    s_waitcnt vmcnt(0)
    s_mov_b64 exec, 15
    buffer_atomic_add v14, v13, s[16:19], s75 offen
    s_mov_b64 exec, -1
    v_mov_b32 v38, 0
    s_mov_b64 exec, 1
    buffer_atomic_add v38, v15, s[16:19], s74 offen sc0
    s_mov_b64 exec, -1
    v_lshrrev_b32 v53, 5, v0
    v_and_b32 v3, 31, v0
    v_lshlrev_b32 v51, 2, v3
    v_bfe_u32 v4, v0, 2, 2
    v_lshl_add_u32 v52, v53, 2, v4
    v_bfe_u32 v6, v0, 4, 1
    v_lshlrev_b32 v6, 1, v6
    v_bfe_u32 v8, v0, 1, 1
    v_add_u32 v6, v6, v8
    v_bfe_u32 v8, v0, 3, 1
    v_lshlrev_b32 v8, 2, v8
    v_xor_b32 v6, v6, v8
    v_lshlrev_b32 v6, 4, v6
    v_lshl_add_u32 v6, v52, 7, v6
    v_and_b32 v8, 1, v0
    v_lshl_add_u32 v40, v8, 3, v6
    v_mov_b32 v39, 0
    s_mov_b64 exec, 1
    buffer_atomic_add v39, v15, s[16:19], s74 offen sc0
    s_mov_b64 exec, -1
    v_xor_b32 v41, 64, v40
    v_add_u32 v42, 0x10000, v40
    v_add_u32 v43, 0x10000, v41
    v_add_u32 v44, 0x20000, v40
    v_add_u32 v45, 0x20000, v41
    v_lshrrev_b32 v55, 2, v0
    v_lshlrev_b32 v55, 12, v55
    v_and_b32 v3, 3, v0
    v_lshl_add_u32 v55, v3, 4, v55
    v_lshlrev_b32 v56, 6, v52
    v_bfe_u32 v6, v0, 4, 1
    v_lshl_add_u32 v56, v6, 5, v56
    v_lshl_add_u32 v56, v3, 3, v56
    v_add_u32 v56, s70, v56
    v_and_b32 v57, 31, v0
    v_lshlrev_b32 v57, 11, v57
    v_lshl_add_u32 v57, v53, 4, v57
    v_mov_b32 v9, 0
    s_mov_b64 exec, 1
    buffer_atomic_add v9, v15, s[16:19], s74 offen sc0
    s_mov_b64 exec, -1
    s_mov_b32 s55, 0
L_ppo:
    s_waitcnt vmcnt(2)
    v_readfirstlane_b32 s54, v38
    s_nop 0
    s_cmp_ge_u32 s54, 32
    s_cbranch_scc1 L_ppdo
    v_mov_b32 v38, 0
    s_mov_b64 exec, 1
    buffer_atomic_add v38, v15, s[16:19], s74 offen sc0
    s_mov_b64 exec, -1
    s_waitcnt vmcnt(2)
    v_readfirstlane_b32 s54, v39
    s_nop 0
    s_cmp_ge_u32 s54, 32
    s_cbranch_scc1 L_ppdo
    v_mov_b32 v39, 0
    s_mov_b64 exec, 1
    buffer_atomic_add v39, v15, s[16:19], s74 offen sc0
    s_mov_b64 exec, -1
    s_waitcnt vmcnt(2)
    v_readfirstlane_b32 s54, v9
    s_nop 0
    s_cmp_ge_u32 s54, 32
    s_cbranch_scc1 L_ppdo
    v_mov_b32 v9, 0
    s_mov_b64 exec, 1
    buffer_atomic_add v9, v15, s[16:19], s74 offen sc0
    s_mov_b64 exec, -1
    s_add_u32 s55, s55, 1
    s_cmp_lt_u32 s55, 0x20000
    s_cbranch_scc1 L_ppo
L_ppdo:
    s_add_u32 s44, s63, 0
    buffer_load_dwordx4 v[92:95], v10, s[16:19], s44 offen offset:0 sc1
    buffer_load_dwordx4 v[96:99], v10, s[16:19], s44 offen offset:1024 sc1
    buffer_load_dwordx4 v[100:103], v10, s[16:19], s44 offen offset:2048 sc1
    buffer_load_dwordx4 v[104:107], v10, s[16:19], s44 offen offset:3072 sc1
    s_add_u32 s44, s63, 4096
    buffer_load_dwordx4 v[108:111], v10, s[16:19], s44 offen offset:0 sc1
    buffer_load_dwordx4 v[112:115], v10, s[16:19], s44 offen offset:1024 sc1
    buffer_load_dwordx4 v[116:119], v10, s[16:19], s44 offen offset:2048 sc1
    buffer_load_dwordx4 v[120:123], v10, s[16:19], s44 offen offset:3072 sc1
    s_add_u32 s44, s63, 8192
    buffer_load_dwordx4 v[124:127], v10, s[16:19], s44 offen offset:0 sc1
    buffer_load_dwordx4 v[128:131], v10, s[16:19], s44 offen offset:1024 sc1
    buffer_load_dwordx4 v[132:135], v10, s[16:19], s44 offen offset:2048 sc1
    buffer_load_dwordx4 v[136:139], v10, s[16:19], s44 offen offset:3072 sc1
    s_add_u32 s44, s63, 12288
    buffer_load_dwordx4 v[140:143], v10, s[16:19], s44 offen offset:0 sc1
    buffer_load_dwordx4 v[144:147], v10, s[16:19], s44 offen offset:1024 sc1
    buffer_load_dwordx4 v[148:151], v10, s[16:19], s44 offen offset:2048 sc1
    buffer_load_dwordx4 v[152:155], v10, s[16:19], s44 offen offset:3072 sc1
    s_add_u32 s58, s58, 4
    s_mov_b64 exec, 1
    ds_add_u32 v36, v14 offset:0
    s_mov_b64 exec, -1
    ds_read_b32 v37, v36
    s_waitcnt lgkmcnt(0)
    v_readfirstlane_b32 s54, v37
    s_nop 0
    s_cmp_ge_u32 s54, s58
    s_cbranch_scc1 L_cb0
L_cr0:
    ds_read_b32 v37, v36
    s_waitcnt lgkmcnt(0)
    v_readfirstlane_b32 s54, v37
    s_nop 0
    s_cmp_lt_u32 s54, s58
    s_cbranch_scc1 L_cr0
L_cb0:
    ds_read_b64_tr_b16 v[220:221], v40 offset:0
    ds_read_b64_tr_b16 v[222:223], v40 offset:1024
    ds_read_b64_tr_b16 v[224:225], v41 offset:0
    ds_read_b64_tr_b16 v[226:227], v41 offset:1024
    ds_read_b64_tr_b16 v[228:229], v40 offset:2048
    ds_read_b64_tr_b16 v[230:231], v40 offset:3072
    ds_read_b64_tr_b16 v[232:233], v41 offset:2048
    ds_read_b64_tr_b16 v[234:235], v41 offset:3072
    ds_read_b64_tr_b16 v[236:237], v40 offset:4096
    ds_read_b64_tr_b16 v[238:239], v40 offset:5120
    ds_read_b64_tr_b16 v[240:241], v41 offset:4096
    ds_read_b64_tr_b16 v[242:243], v41 offset:5120
    ds_read_b64_tr_b16 v[244:245], v40 offset:6144
    ds_read_b64_tr_b16 v[246:247], v40 offset:7168
    ds_read_b64_tr_b16 v[248:249], v41 offset:6144
    ds_read_b64_tr_b16 v[250:251], v41 offset:7168
    s_waitcnt vmcnt(8)
    s_setprio 0
    s_waitcnt lgkmcnt(8)
    v_mfma_f32_32x32x16_bf16 v[60:75], v[220:223], v[92:95], 0
    ds_read_b64_tr_b16 v[20:21], v40 offset:8192
    ds_read_b64_tr_b16 v[22:23], v40 offset:9216
    s_add_u32 s71, s63, 16384
    buffer_load_dwordx4 v[156:159], v10, s[16:19], s71 offen offset:0 sc1
    v_mfma_f32_32x32x16_bf16 v[76:91], v[224:227], v[92:95], 0
    ds_read_b64_tr_b16 v[24:25], v41 offset:8192
    ds_read_b64_tr_b16 v[26:27], v41 offset:9216
    s_add_u32 s71, s63, 16384
    buffer_load_dwordx4 v[160:163], v10, s[16:19], s71 offen offset:1024 sc1
    v_mfma_f32_32x32x16_bf16 v[60:75], v[228:231], v[96:99], v[60:75]
    ds_read_b64_tr_b16 v[28:29], v40 offset:10240
    ds_read_b64_tr_b16 v[30:31], v40 offset:11264
    s_add_u32 s71, s63, 16384
    buffer_load_dwordx4 v[164:167], v10, s[16:19], s71 offen offset:2048 sc1
    v_mfma_f32_32x32x16_bf16 v[76:91], v[232:235], v[96:99], v[76:91]
    ds_read_b64_tr_b16 v[32:33], v41 offset:10240
    ds_read_b64_tr_b16 v[34:35], v41 offset:11264
    s_add_u32 s71, s63, 16384
    buffer_load_dwordx4 v[168:171], v10, s[16:19], s71 offen offset:3072 sc1
    s_add_u32 s44, s63, 32768
    buffer_load_dwordx4 v[92:95], v10, s[16:19], s44 offen offset:0 sc1
    buffer_load_dwordx4 v[96:99], v10, s[16:19], s44 offen offset:1024 sc1
    s_waitcnt lgkmcnt(8)
    v_mfma_f32_32x32x16_bf16 v[60:75], v[236:239], v[100:103], v[60:75]
    ds_read_b64_tr_b16 v[220:221], v40 offset:12288
    ds_read_b64_tr_b16 v[222:223], v40 offset:13312
    s_add_u32 s71, s63, 20480
    buffer_load_dwordx4 v[172:175], v10, s[16:19], s71 offen offset:0 sc1
    v_mfma_f32_32x32x16_bf16 v[76:91], v[240:243], v[100:103], v[76:91]
    ds_read_b64_tr_b16 v[224:225], v41 offset:12288
    ds_read_b64_tr_b16 v[226:227], v41 offset:13312
    s_add_u32 s71, s63, 20480
    buffer_load_dwordx4 v[176:179], v10, s[16:19], s71 offen offset:1024 sc1
    v_mfma_f32_32x32x16_bf16 v[60:75], v[244:247], v[104:107], v[60:75]
    ds_read_b64_tr_b16 v[228:229], v40 offset:14336
    ds_read_b64_tr_b16 v[230:231], v40 offset:15360
    s_add_u32 s71, s63, 20480
    buffer_load_dwordx4 v[180:183], v10, s[16:19], s71 offen offset:2048 sc1
    v_mfma_f32_32x32x16_bf16 v[76:91], v[248:251], v[104:107], v[76:91]
    ds_read_b64_tr_b16 v[232:233], v41 offset:14336
    ds_read_b64_tr_b16 v[234:235], v41 offset:15360
    s_add_u32 s71, s63, 20480
    buffer_load_dwordx4 v[184:187], v10, s[16:19], s71 offen offset:3072 sc1
    buffer_load_dwordx4 v[100:103], v10, s[16:19], s44 offen offset:2048 sc1
    buffer_load_dwordx4 v[104:107], v10, s[16:19], s44 offen offset:3072 sc1
    s_waitcnt lgkmcnt(8)
    v_mfma_f32_32x32x16_bf16 v[60:75], v[20:23], v[108:111], v[60:75]
    ds_read_b64_tr_b16 v[236:237], v40 offset:16384
    ds_read_b64_tr_b16 v[238:239], v40 offset:17408
    s_add_u32 s71, s63, 24576
    buffer_load_dwordx4 v[188:191], v10, s[16:19], s71 offen offset:0 sc1
    v_mfma_f32_32x32x16_bf16 v[76:91], v[24:27], v[108:111], v[76:91]
    ds_read_b64_tr_b16 v[240:241], v41 offset:16384
    ds_read_b64_tr_b16 v[242:243], v41 offset:17408
    s_add_u32 s71, s63, 24576
    buffer_load_dwordx4 v[192:195], v10, s[16:19], s71 offen offset:1024 sc1
    v_mfma_f32_32x32x16_bf16 v[60:75], v[28:31], v[112:115], v[60:75]
    ds_read_b64_tr_b16 v[244:245], v40 offset:18432
    ds_read_b64_tr_b16 v[246:247], v40 offset:19456
    s_add_u32 s71, s63, 24576
    buffer_load_dwordx4 v[196:199], v10, s[16:19], s71 offen offset:2048 sc1
    v_mfma_f32_32x32x16_bf16 v[76:91], v[32:35], v[112:115], v[76:91]
    ds_read_b64_tr_b16 v[248:249], v41 offset:18432
    ds_read_b64_tr_b16 v[250:251], v41 offset:19456
    s_add_u32 s71, s63, 24576
    buffer_load_dwordx4 v[200:203], v10, s[16:19], s71 offen offset:3072 sc1
    s_add_u32 s44, s63, 36864
    buffer_load_dwordx4 v[108:111], v10, s[16:19], s44 offen offset:0 sc1
    buffer_load_dwordx4 v[112:115], v10, s[16:19], s44 offen offset:1024 sc1
    s_waitcnt vmcnt(18)
    s_waitcnt lgkmcnt(8)
    v_mfma_f32_32x32x16_bf16 v[60:75], v[220:223], v[116:119], v[60:75]
    ds_read_b64_tr_b16 v[20:21], v40 offset:20480
    ds_read_b64_tr_b16 v[22:23], v40 offset:21504
    s_add_u32 s71, s63, 28672
    buffer_load_dwordx4 v[204:207], v10, s[16:19], s71 offen offset:0 sc1
    v_mfma_f32_32x32x16_bf16 v[76:91], v[224:227], v[116:119], v[76:91]
    ds_read_b64_tr_b16 v[24:25], v41 offset:20480
    ds_read_b64_tr_b16 v[26:27], v41 offset:21504
    s_add_u32 s71, s63, 28672
    buffer_load_dwordx4 v[208:211], v10, s[16:19], s71 offen offset:1024 sc1
    v_mfma_f32_32x32x16_bf16 v[60:75], v[228:231], v[120:123], v[60:75]
    ds_read_b64_tr_b16 v[28:29], v40 offset:22528
    ds_read_b64_tr_b16 v[30:31], v40 offset:23552
    s_add_u32 s71, s63, 28672
    buffer_load_dwordx4 v[212:215], v10, s[16:19], s71 offen offset:2048 sc1
    v_mfma_f32_32x32x16_bf16 v[76:91], v[232:235], v[120:123], v[76:91]
    ds_read_b64_tr_b16 v[32:33], v41 offset:22528
    ds_read_b64_tr_b16 v[34:35], v41 offset:23552
    s_add_u32 s71, s63, 28672
    buffer_load_dwordx4 v[216:219], v10, s[16:19], s71 offen offset:3072 sc1
    buffer_load_dwordx4 v[116:119], v10, s[16:19], s44 offen offset:2048 sc1
    buffer_load_dwordx4 v[120:123], v10, s[16:19], s44 offen offset:3072 sc1
    s_waitcnt lgkmcnt(8)
    v_mfma_f32_32x32x16_bf16 v[60:75], v[236:239], v[124:127], v[60:75]
    ds_read_b64_tr_b16 v[220:221], v40 offset:24576
    ds_read_b64_tr_b16 v[222:223], v40 offset:25600
    v_mfma_f32_32x32x16_bf16 v[76:91], v[240:243], v[124:127], v[76:91]
    ds_read_b64_tr_b16 v[224:225], v41 offset:24576
    ds_read_b64_tr_b16 v[226:227], v41 offset:25600
    v_mfma_f32_32x32x16_bf16 v[60:75], v[244:247], v[128:131], v[60:75]
    ds_read_b64_tr_b16 v[228:229], v40 offset:26624
    ds_read_b64_tr_b16 v[230:231], v40 offset:27648
    v_mfma_f32_32x32x16_bf16 v[76:91], v[248:251], v[128:131], v[76:91]
    ds_read_b64_tr_b16 v[232:233], v41 offset:26624
    ds_read_b64_tr_b16 v[234:235], v41 offset:27648
    s_add_u32 s44, s63, 40960
    buffer_load_dwordx4 v[124:127], v10, s[16:19], s44 offen offset:0 sc1
    buffer_load_dwordx4 v[128:131], v10, s[16:19], s44 offen offset:1024 sc1
    s_waitcnt lgkmcnt(8)
    v_mfma_f32_32x32x16_bf16 v[60:75], v[20:23], v[132:135], v[60:75]
    ds_read_b64_tr_b16 v[236:237], v40 offset:28672
    ds_read_b64_tr_b16 v[238:239], v40 offset:29696
    v_mfma_f32_32x32x16_bf16 v[76:91], v[24:27], v[132:135], v[76:91]
    ds_read_b64_tr_b16 v[240:241], v41 offset:28672
    ds_read_b64_tr_b16 v[242:243], v41 offset:29696
    v_mfma_f32_32x32x16_bf16 v[60:75], v[28:31], v[136:139], v[60:75]
    ds_read_b64_tr_b16 v[244:245], v40 offset:30720
    ds_read_b64_tr_b16 v[246:247], v40 offset:31744
    v_mfma_f32_32x32x16_bf16 v[76:91], v[32:35], v[136:139], v[76:91]
    ds_read_b64_tr_b16 v[248:249], v41 offset:30720
    ds_read_b64_tr_b16 v[250:251], v41 offset:31744
    buffer_load_dwordx4 v[132:135], v10, s[16:19], s44 offen offset:2048 sc1
    buffer_load_dwordx4 v[136:139], v10, s[16:19], s44 offen offset:3072 sc1
    s_waitcnt lgkmcnt(8)
    v_mfma_f32_32x32x16_bf16 v[60:75], v[220:223], v[140:143], v[60:75]
    ds_read_b64_tr_b16 v[20:21], v40 offset:59392
    ds_read_b64_tr_b16 v[22:23], v40 offset:60416
    v_mfma_f32_32x32x16_bf16 v[76:91], v[224:227], v[140:143], v[76:91]
    ds_read_b64_tr_b16 v[24:25], v41 offset:59392
    ds_read_b64_tr_b16 v[26:27], v41 offset:60416
    v_mfma_f32_32x32x16_bf16 v[60:75], v[228:231], v[144:147], v[60:75]
    ds_read_b64_tr_b16 v[28:29], v40 offset:61440
    ds_read_b64_tr_b16 v[30:31], v40 offset:62464
    v_mfma_f32_32x32x16_bf16 v[76:91], v[232:235], v[144:147], v[76:91]
    ds_read_b64_tr_b16 v[32:33], v41 offset:61440
    ds_read_b64_tr_b16 v[34:35], v41 offset:62464
    s_add_u32 s44, s63, 45056
    buffer_load_dwordx4 v[140:143], v10, s[16:19], s44 offen offset:0 sc1
    buffer_load_dwordx4 v[144:147], v10, s[16:19], s44 offen offset:1024 sc1
    s_waitcnt vmcnt(20)
    s_waitcnt lgkmcnt(8)
    v_mfma_f32_32x32x16_bf16 v[60:75], v[236:239], v[148:151], v[60:75]
    ds_read_b64_tr_b16 v[220:221], v40 offset:63488
    ds_read_b64_tr_b16 v[222:223], v40 offset:64512
    v_mfma_f32_32x32x16_bf16 v[76:91], v[240:243], v[148:151], v[76:91]
    ds_read_b64_tr_b16 v[224:225], v41 offset:63488
    ds_read_b64_tr_b16 v[226:227], v41 offset:64512
    v_mfma_f32_32x32x16_bf16 v[60:75], v[244:247], v[152:155], v[60:75]
    ds_read_b64_tr_b16 v[228:229], v42 offset:0
    ds_read_b64_tr_b16 v[230:231], v42 offset:1024
    v_mfma_f32_32x32x16_bf16 v[76:91], v[248:251], v[152:155], v[76:91]
    ds_read_b64_tr_b16 v[232:233], v43 offset:0
    ds_read_b64_tr_b16 v[234:235], v43 offset:1024
    buffer_load_dwordx4 v[148:151], v10, s[16:19], s44 offen offset:2048 sc1
    buffer_load_dwordx4 v[152:155], v10, s[16:19], s44 offen offset:3072 sc1
    s_waitcnt lgkmcnt(8)
    v_mfma_f32_32x32x16_bf16 v[60:75], v[20:23], v[156:159], v[60:75]
    ds_read_b64_tr_b16 v[236:237], v42 offset:2048
    ds_read_b64_tr_b16 v[238:239], v42 offset:3072
    v_mfma_f32_32x32x16_bf16 v[76:91], v[24:27], v[156:159], v[76:91]
    ds_read_b64_tr_b16 v[240:241], v43 offset:2048
    ds_read_b64_tr_b16 v[242:243], v43 offset:3072
    v_mfma_f32_32x32x16_bf16 v[60:75], v[28:31], v[160:163], v[60:75]
    ds_read_b64_tr_b16 v[244:245], v42 offset:4096
    ds_read_b64_tr_b16 v[246:247], v42 offset:5120
    v_mfma_f32_32x32x16_bf16 v[76:91], v[32:35], v[160:163], v[76:91]
    ds_read_b64_tr_b16 v[248:249], v43 offset:4096
    ds_read_b64_tr_b16 v[250:251], v43 offset:5120
    s_add_u32 s44, s63, 49152
    buffer_load_dwordx4 v[156:159], v10, s[16:19], s44 offen offset:0 sc1
    buffer_load_dwordx4 v[160:163], v10, s[16:19], s44 offen offset:1024 sc1
    s_waitcnt lgkmcnt(8)
    v_mfma_f32_32x32x16_bf16 v[60:75], v[220:223], v[164:167], v[60:75]
    ds_read_b64_tr_b16 v[20:21], v42 offset:6144
    ds_read_b64_tr_b16 v[22:23], v42 offset:7168
    v_mfma_f32_32x32x16_bf16 v[76:91], v[224:227], v[164:167], v[76:91]
    ds_read_b64_tr_b16 v[24:25], v43 offset:6144
    ds_read_b64_tr_b16 v[26:27], v43 offset:7168
    v_mfma_f32_32x32x16_bf16 v[60:75], v[228:231], v[168:171], v[60:75]
    ds_read_b64_tr_b16 v[28:29], v42 offset:8192
    ds_read_b64_tr_b16 v[30:31], v42 offset:9216
    ds_read_b32 v37, v36 offset:16
    v_mfma_f32_32x32x16_bf16 v[76:91], v[232:235], v[168:171], v[76:91]
    ds_read_b64_tr_b16 v[32:33], v43 offset:8192
    ds_read_b64_tr_b16 v[34:35], v43 offset:9216
    buffer_load_dwordx4 v[164:167], v10, s[16:19], s44 offen offset:2048 sc1
    buffer_load_dwordx4 v[168:171], v10, s[16:19], s44 offen offset:3072 sc1
    s_waitcnt lgkmcnt(2)
    v_readfirstlane_b32 s54, v37
    s_nop 0
    s_cmp_ge_u32 s54, 4
    s_cbranch_scc1 L_w2
L_lww:
    ds_read_b32 v37, v36 offset:16
    s_waitcnt lgkmcnt(0)
    v_readfirstlane_b32 s54, v37
    s_nop 0
    s_cmp_ge_u32 s54, 4
    s_cbranch_scc1 L_low
    s_sleep 1
    s_branch L_lww
L_low:
L_w2:
    v_mfma_f32_32x32x16_bf16 v[60:75], v[236:239], v[172:175], v[60:75]
    ds_read_b64_tr_b16 v[220:221], v42 offset:14336
    ds_read_b64_tr_b16 v[222:223], v42 offset:15360
    v_mfma_f32_32x32x16_bf16 v[76:91], v[240:243], v[172:175], v[76:91]
    ds_read_b64_tr_b16 v[224:225], v43 offset:14336
    ds_read_b64_tr_b16 v[226:227], v43 offset:15360
    v_mfma_f32_32x32x16_bf16 v[60:75], v[244:247], v[176:179], v[60:75]
    ds_read_b64_tr_b16 v[228:229], v42 offset:16384
    ds_read_b64_tr_b16 v[230:231], v42 offset:17408
    v_mfma_f32_32x32x16_bf16 v[76:91], v[248:251], v[176:179], v[76:91]
    ds_read_b64_tr_b16 v[232:233], v43 offset:16384
    ds_read_b64_tr_b16 v[234:235], v43 offset:17408
    s_add_u32 s44, s63, 53248
    buffer_load_dwordx4 v[172:175], v10, s[16:19], s44 offen offset:0 sc1
    buffer_load_dwordx4 v[176:179], v10, s[16:19], s44 offen offset:1024 sc1
    s_waitcnt vmcnt(16)
    s_waitcnt lgkmcnt(8)
    v_mfma_f32_32x32x16_bf16 v[60:75], v[20:23], v[180:183], v[60:75]
    ds_read_b64_tr_b16 v[236:237], v42 offset:18432
    ds_read_b64_tr_b16 v[238:239], v42 offset:19456
    v_mfma_f32_32x32x16_bf16 v[76:91], v[24:27], v[180:183], v[76:91]
    ds_read_b64_tr_b16 v[240:241], v43 offset:18432
    ds_read_b64_tr_b16 v[242:243], v43 offset:19456
    v_mfma_f32_32x32x16_bf16 v[60:75], v[28:31], v[184:187], v[60:75]
    ds_read_b64_tr_b16 v[244:245], v42 offset:20480
    ds_read_b64_tr_b16 v[246:247], v42 offset:21504
    v_mfma_f32_32x32x16_bf16 v[76:91], v[32:35], v[184:187], v[76:91]
    ds_read_b64_tr_b16 v[248:249], v43 offset:20480
    ds_read_b64_tr_b16 v[250:251], v43 offset:21504
    buffer_load_dwordx4 v[180:183], v10, s[16:19], s44 offen offset:2048 sc1
    buffer_load_dwordx4 v[184:187], v10, s[16:19], s44 offen offset:3072 sc1
    s_waitcnt lgkmcnt(8)
    v_mfma_f32_32x32x16_bf16 v[60:75], v[220:223], v[188:191], v[60:75]
    ds_read_b64_tr_b16 v[20:21], v42 offset:22528
    ds_read_b64_tr_b16 v[22:23], v42 offset:23552
    v_mfma_f32_32x32x16_bf16 v[76:91], v[224:227], v[188:191], v[76:91]
    ds_read_b64_tr_b16 v[24:25], v43 offset:22528
    ds_read_b64_tr_b16 v[26:27], v43 offset:23552
    v_mfma_f32_32x32x16_bf16 v[60:75], v[228:231], v[192:195], v[60:75]
    ds_read_b64_tr_b16 v[28:29], v42 offset:24576
    ds_read_b64_tr_b16 v[30:31], v42 offset:25600
    v_mfma_f32_32x32x16_bf16 v[76:91], v[232:235], v[192:195], v[76:91]
    ds_read_b64_tr_b16 v[32:33], v43 offset:24576
    ds_read_b64_tr_b16 v[34:35], v43 offset:25600
    s_add_u32 s44, s63, 57344
    buffer_load_dwordx4 v[188:191], v10, s[16:19], s44 offen offset:0 sc1
    buffer_load_dwordx4 v[192:195], v10, s[16:19], s44 offen offset:1024 sc1
    s_waitcnt lgkmcnt(8)
    v_mfma_f32_32x32x16_bf16 v[60:75], v[236:239], v[196:199], v[60:75]
    ds_read_b64_tr_b16 v[220:221], v42 offset:26624
    ds_read_b64_tr_b16 v[222:223], v42 offset:27648
    v_mfma_f32_32x32x16_bf16 v[76:91], v[240:243], v[196:199], v[76:91]
    ds_read_b64_tr_b16 v[224:225], v43 offset:26624
    ds_read_b64_tr_b16 v[226:227], v43 offset:27648
    v_mfma_f32_32x32x16_bf16 v[60:75], v[244:247], v[200:203], v[60:75]
    ds_read_b64_tr_b16 v[228:229], v42 offset:28672
    ds_read_b64_tr_b16 v[230:231], v42 offset:29696
    v_mfma_f32_32x32x16_bf16 v[76:91], v[248:251], v[200:203], v[76:91]
    ds_read_b64_tr_b16 v[232:233], v43 offset:28672
    ds_read_b64_tr_b16 v[234:235], v43 offset:29696
    buffer_load_dwordx4 v[196:199], v10, s[16:19], s44 offen offset:2048 sc1
    buffer_load_dwordx4 v[200:203], v10, s[16:19], s44 offen offset:3072 sc1
    s_waitcnt lgkmcnt(8)
    v_mfma_f32_32x32x16_bf16 v[60:75], v[20:23], v[204:207], v[60:75]
    ds_read_b64_tr_b16 v[236:237], v42 offset:30720
    ds_read_b64_tr_b16 v[238:239], v42 offset:31744
    v_mfma_f32_32x32x16_bf16 v[76:91], v[24:27], v[204:207], v[76:91]
    ds_read_b64_tr_b16 v[240:241], v43 offset:30720
    ds_read_b64_tr_b16 v[242:243], v43 offset:31744
    v_mfma_f32_32x32x16_bf16 v[60:75], v[28:31], v[208:211], v[60:75]
    ds_read_b64_tr_b16 v[244:245], v42 offset:32768
    ds_read_b64_tr_b16 v[246:247], v42 offset:33792
    v_mfma_f32_32x32x16_bf16 v[76:91], v[32:35], v[208:211], v[76:91]
    ds_read_b64_tr_b16 v[248:249], v43 offset:32768
    ds_read_b64_tr_b16 v[250:251], v43 offset:33792
    s_add_u32 s44, s63, 61440
    buffer_load_dwordx4 v[204:207], v10, s[16:19], s44 offen offset:0 sc1
    buffer_load_dwordx4 v[208:211], v10, s[16:19], s44 offen offset:1024 sc1
    s_waitcnt vmcnt(22)
    s_waitcnt lgkmcnt(8)
    v_mfma_f32_32x32x16_bf16 v[60:75], v[220:223], v[212:215], v[60:75]
    ds_read_b64_tr_b16 v[20:21], v42 offset:34816
    ds_read_b64_tr_b16 v[22:23], v42 offset:35840
    v_mfma_f32_32x32x16_bf16 v[76:91], v[224:227], v[212:215], v[76:91]
    ds_read_b64_tr_b16 v[24:25], v43 offset:34816
    ds_read_b64_tr_b16 v[26:27], v43 offset:35840
    v_mfma_f32_32x32x16_bf16 v[60:75], v[228:231], v[216:219], v[60:75]
    ds_read_b64_tr_b16 v[28:29], v42 offset:36864
    ds_read_b64_tr_b16 v[30:31], v42 offset:37888
    v_mfma_f32_32x32x16_bf16 v[76:91], v[232:235], v[216:219], v[76:91]
    ds_read_b64_tr_b16 v[32:33], v43 offset:36864
    ds_read_b64_tr_b16 v[34:35], v43 offset:37888
    buffer_load_dwordx4 v[212:215], v10, s[16:19], s44 offen offset:2048 sc1
    buffer_load_dwordx4 v[216:219], v10, s[16:19], s44 offen offset:3072 sc1
    s_waitcnt lgkmcnt(8)
    v_mfma_f32_32x32x16_bf16 v[60:75], v[236:239], v[92:95], v[60:75]
    ds_read_b64_tr_b16 v[220:221], v42 offset:38912
    ds_read_b64_tr_b16 v[222:223], v42 offset:39936
    v_mfma_f32_32x32x16_bf16 v[76:91], v[240:243], v[92:95], v[76:91]
    ds_read_b64_tr_b16 v[224:225], v43 offset:38912
    ds_read_b64_tr_b16 v[226:227], v43 offset:39936
    v_mfma_f32_32x32x16_bf16 v[60:75], v[244:247], v[96:99], v[60:75]
    ds_read_b64_tr_b16 v[228:229], v42 offset:40960
    ds_read_b64_tr_b16 v[230:231], v42 offset:41984
    v_mfma_f32_32x32x16_bf16 v[76:91], v[248:251], v[96:99], v[76:91]
    ds_read_b64_tr_b16 v[232:233], v43 offset:40960
    ds_read_b64_tr_b16 v[234:235], v43 offset:41984
    v_mov_b32 v54, 0
    s_mov_b64 exec, 1
    buffer_atomic_add v54, v15, s[16:19], s64 offen sc0
    s_mov_b64 exec, -1
    s_waitcnt lgkmcnt(8)
    v_mfma_f32_32x32x16_bf16 v[60:75], v[20:23], v[100:103], v[60:75]
    ds_read_b64_tr_b16 v[236:237], v42 offset:43008
    ds_read_b64_tr_b16 v[238:239], v42 offset:44032
    v_mfma_f32_32x32x16_bf16 v[76:91], v[24:27], v[100:103], v[76:91]
    ds_read_b64_tr_b16 v[240:241], v43 offset:43008
    ds_read_b64_tr_b16 v[242:243], v43 offset:44032
    v_mfma_f32_32x32x16_bf16 v[60:75], v[28:31], v[104:107], v[60:75]
    ds_read_b64_tr_b16 v[244:245], v42 offset:45056
    ds_read_b64_tr_b16 v[246:247], v42 offset:46080
    v_mfma_f32_32x32x16_bf16 v[76:91], v[32:35], v[104:107], v[76:91]
    ds_read_b64_tr_b16 v[248:249], v43 offset:45056
    ds_read_b64_tr_b16 v[250:251], v43 offset:46080
    s_waitcnt lgkmcnt(8)
    v_mfma_f32_32x32x16_bf16 v[60:75], v[220:223], v[108:111], v[60:75]
    ds_read_b64_tr_b16 v[20:21], v42 offset:47104
    ds_read_b64_tr_b16 v[22:23], v42 offset:48128
    v_mfma_f32_32x32x16_bf16 v[76:91], v[224:227], v[108:111], v[76:91]
    ds_read_b64_tr_b16 v[24:25], v43 offset:47104
    ds_read_b64_tr_b16 v[26:27], v43 offset:48128
    v_mfma_f32_32x32x16_bf16 v[60:75], v[228:231], v[112:115], v[60:75]
    ds_read_b64_tr_b16 v[28:29], v42 offset:49152
    ds_read_b64_tr_b16 v[30:31], v42 offset:50176
    v_mfma_f32_32x32x16_bf16 v[76:91], v[232:235], v[112:115], v[76:91]
    ds_read_b64_tr_b16 v[32:33], v43 offset:49152
    ds_read_b64_tr_b16 v[34:35], v43 offset:50176
    s_waitcnt vmcnt(17)
    s_waitcnt lgkmcnt(8)
    v_mfma_f32_32x32x16_bf16 v[60:75], v[236:239], v[116:119], v[60:75]
    ds_read_b64_tr_b16 v[220:221], v42 offset:51200
    ds_read_b64_tr_b16 v[222:223], v42 offset:52224
    v_mfma_f32_32x32x16_bf16 v[76:91], v[240:243], v[116:119], v[76:91]
    ds_read_b64_tr_b16 v[224:225], v43 offset:51200
    ds_read_b64_tr_b16 v[226:227], v43 offset:52224
    v_mfma_f32_32x32x16_bf16 v[60:75], v[244:247], v[120:123], v[60:75]
    ds_read_b64_tr_b16 v[228:229], v42 offset:53248
    ds_read_b64_tr_b16 v[230:231], v42 offset:54272
    v_mfma_f32_32x32x16_bf16 v[76:91], v[248:251], v[120:123], v[76:91]
    ds_read_b64_tr_b16 v[232:233], v43 offset:53248
    ds_read_b64_tr_b16 v[234:235], v43 offset:54272
    s_waitcnt lgkmcnt(8)
    v_mfma_f32_32x32x16_bf16 v[60:75], v[20:23], v[124:127], v[60:75]
    ds_read_b64_tr_b16 v[236:237], v42 offset:55296
    ds_read_b64_tr_b16 v[238:239], v42 offset:56320
    v_mfma_f32_32x32x16_bf16 v[76:91], v[24:27], v[124:127], v[76:91]
    ds_read_b64_tr_b16 v[240:241], v43 offset:55296
    ds_read_b64_tr_b16 v[242:243], v43 offset:56320
    v_mfma_f32_32x32x16_bf16 v[60:75], v[28:31], v[128:131], v[60:75]
    ds_read_b64_tr_b16 v[244:245], v42 offset:57344
    ds_read_b64_tr_b16 v[246:247], v42 offset:58368
    v_mfma_f32_32x32x16_bf16 v[76:91], v[32:35], v[128:131], v[76:91]
    ds_read_b64_tr_b16 v[248:249], v43 offset:57344
    ds_read_b64_tr_b16 v[250:251], v43 offset:58368
    s_waitcnt lgkmcnt(8)
    v_mfma_f32_32x32x16_bf16 v[60:75], v[220:223], v[132:135], v[60:75]
    ds_read_b64_tr_b16 v[20:21], v42 offset:59392
    ds_read_b64_tr_b16 v[22:23], v42 offset:60416
    v_mfma_f32_32x32x16_bf16 v[76:91], v[224:227], v[132:135], v[76:91]
    ds_read_b64_tr_b16 v[24:25], v43 offset:59392
    ds_read_b64_tr_b16 v[26:27], v43 offset:60416
    v_mfma_f32_32x32x16_bf16 v[60:75], v[228:231], v[136:139], v[60:75]
    ds_read_b64_tr_b16 v[28:29], v42 offset:61440
    ds_read_b64_tr_b16 v[30:31], v42 offset:62464
    v_mfma_f32_32x32x16_bf16 v[76:91], v[232:235], v[136:139], v[76:91]
    ds_read_b64_tr_b16 v[32:33], v43 offset:61440
    ds_read_b64_tr_b16 v[34:35], v43 offset:62464
    s_waitcnt lgkmcnt(8)
    v_mfma_f32_32x32x16_bf16 v[60:75], v[236:239], v[140:143], v[60:75]
    ds_read_b64_tr_b16 v[220:221], v42 offset:63488
    ds_read_b64_tr_b16 v[222:223], v42 offset:64512
    v_mfma_f32_32x32x16_bf16 v[76:91], v[240:243], v[140:143], v[76:91]
    ds_read_b64_tr_b16 v[224:225], v43 offset:63488
    ds_read_b64_tr_b16 v[226:227], v43 offset:64512
    v_mfma_f32_32x32x16_bf16 v[60:75], v[244:247], v[144:147], v[60:75]
    ds_read_b64_tr_b16 v[228:229], v44 offset:0
    ds_read_b64_tr_b16 v[230:231], v44 offset:1024
    v_mfma_f32_32x32x16_bf16 v[76:91], v[248:251], v[144:147], v[76:91]
    ds_read_b64_tr_b16 v[232:233], v45 offset:0
    ds_read_b64_tr_b16 v[234:235], v45 offset:1024
    s_waitcnt vmcnt(9)
    s_waitcnt lgkmcnt(8)
    v_mfma_f32_32x32x16_bf16 v[60:75], v[20:23], v[148:151], v[60:75]
    ds_read_b64_tr_b16 v[236:237], v44 offset:2048
    ds_read_b64_tr_b16 v[238:239], v44 offset:3072
    v_mfma_f32_32x32x16_bf16 v[76:91], v[24:27], v[148:151], v[76:91]
    ds_read_b64_tr_b16 v[240:241], v45 offset:2048
    ds_read_b64_tr_b16 v[242:243], v45 offset:3072
    v_mfma_f32_32x32x16_bf16 v[60:75], v[28:31], v[152:155], v[60:75]
    ds_read_b64_tr_b16 v[244:245], v44 offset:4096
    ds_read_b64_tr_b16 v[246:247], v44 offset:5120
    v_mfma_f32_32x32x16_bf16 v[76:91], v[32:35], v[152:155], v[76:91]
    ds_read_b64_tr_b16 v[248:249], v45 offset:4096
    ds_read_b64_tr_b16 v[250:251], v45 offset:5120
    s_waitcnt vmcnt(0)
    v_readfirstlane_b32 s54, v54
    s_nop 0
    s_cmp_lt_u32 s54, 64
    s_cbranch_scc1 L_nob
    s_mov_b32 m0, s70
    s_mov_b32 s45, s66
    buffer_load_dwordx4 v55, s[16:19], s45 offen offset:0 sc1 lds
    s_add_u32 s45, s45, 64512
    buffer_load_dwordx4 v55, s[16:19], s45 offen offset:1024 sc1 lds
    s_add_u32 s45, s45, 64512
    buffer_load_dwordx4 v55, s[16:19], s45 offen offset:2048 sc1 lds
    s_add_u32 s45, s45, 64512
    buffer_load_dwordx4 v55, s[16:19], s45 offen offset:3072 sc1 lds
    s_add_u32 s45, s45, 64512
    s_mov_b32 s69, 1
L_nob:
    buffer_load_dword v46, v51, s[16:19], s67 offen sc1
    s_waitcnt lgkmcnt(8)
    v_mfma_f32_32x32x16_bf16 v[60:75], v[220:223], v[156:159], v[60:75]
    ds_read_b64_tr_b16 v[20:21], v44 offset:6144
    ds_read_b64_tr_b16 v[22:23], v44 offset:7168
    v_mfma_f32_32x32x16_bf16 v[76:91], v[224:227], v[156:159], v[76:91]
    ds_read_b64_tr_b16 v[24:25], v45 offset:6144
    ds_read_b64_tr_b16 v[26:27], v45 offset:7168
    v_mfma_f32_32x32x16_bf16 v[60:75], v[228:231], v[160:163], v[60:75]
    ds_read_b64_tr_b16 v[28:29], v44 offset:8192
    ds_read_b64_tr_b16 v[30:31], v44 offset:9216
    v_mfma_f32_32x32x16_bf16 v[76:91], v[232:235], v[160:163], v[76:91]
    ds_read_b64_tr_b16 v[32:33], v45 offset:8192
    ds_read_b64_tr_b16 v[34:35], v45 offset:9216
    s_waitcnt lgkmcnt(8)
    v_mfma_f32_32x32x16_bf16 v[60:75], v[236:239], v[164:167], v[60:75]
    ds_read_b64_tr_b16 v[220:221], v44 offset:10240
    ds_read_b64_tr_b16 v[222:223], v44 offset:11264
    v_mfma_f32_32x32x16_bf16 v[76:91], v[240:243], v[164:167], v[76:91]
    ds_read_b64_tr_b16 v[224:225], v45 offset:10240
    ds_read_b64_tr_b16 v[226:227], v45 offset:11264
    v_mfma_f32_32x32x16_bf16 v[60:75], v[244:247], v[168:171], v[60:75]
    ds_read_b64_tr_b16 v[228:229], v44 offset:12288
    ds_read_b64_tr_b16 v[230:231], v44 offset:13312
    v_mfma_f32_32x32x16_bf16 v[76:91], v[248:251], v[168:171], v[76:91]
    ds_read_b64_tr_b16 v[232:233], v45 offset:12288
    ds_read_b64_tr_b16 v[234:235], v45 offset:13312
    s_waitcnt lgkmcnt(8)
    v_mfma_f32_32x32x16_bf16 v[60:75], v[20:23], v[172:175], v[60:75]
    ds_read_b64_tr_b16 v[236:237], v44 offset:14336
    ds_read_b64_tr_b16 v[238:239], v44 offset:15360
    v_mfma_f32_32x32x16_bf16 v[76:91], v[24:27], v[172:175], v[76:91]
    ds_read_b64_tr_b16 v[240:241], v45 offset:14336
    ds_read_b64_tr_b16 v[242:243], v45 offset:15360
    v_mfma_f32_32x32x16_bf16 v[60:75], v[28:31], v[176:179], v[60:75]
    ds_read_b64_tr_b16 v[244:245], v44 offset:16384
    ds_read_b64_tr_b16 v[246:247], v44 offset:17408
    v_mfma_f32_32x32x16_bf16 v[76:91], v[32:35], v[176:179], v[76:91]
    ds_read_b64_tr_b16 v[248:249], v45 offset:16384
    ds_read_b64_tr_b16 v[250:251], v45 offset:17408
    s_waitcnt lgkmcnt(8)
    v_mfma_f32_32x32x16_bf16 v[60:75], v[220:223], v[180:183], v[60:75]
    ds_read_b64_tr_b16 v[20:21], v44 offset:18432
    ds_read_b64_tr_b16 v[22:23], v44 offset:19456
    v_mfma_f32_32x32x16_bf16 v[76:91], v[224:227], v[180:183], v[76:91]
    ds_read_b64_tr_b16 v[24:25], v45 offset:18432
    ds_read_b64_tr_b16 v[26:27], v45 offset:19456
    v_mfma_f32_32x32x16_bf16 v[60:75], v[228:231], v[184:187], v[60:75]
    ds_read_b64_tr_b16 v[28:29], v44 offset:20480
    ds_read_b64_tr_b16 v[30:31], v44 offset:21504
    v_mfma_f32_32x32x16_bf16 v[76:91], v[232:235], v[184:187], v[76:91]
    ds_read_b64_tr_b16 v[32:33], v45 offset:20480
    ds_read_b64_tr_b16 v[34:35], v45 offset:21504
    s_waitcnt lgkmcnt(8)
    v_mfma_f32_32x32x16_bf16 v[60:75], v[236:239], v[188:191], v[60:75]
    ds_read_b64_tr_b16 v[220:221], v44 offset:22528
    ds_read_b64_tr_b16 v[222:223], v44 offset:23552
    v_and_b32 v166, 31, v0
    v_and_b32 v167, 7, v0
    v_lshlrev_b32 v156, 7, v166
    v_lshl_add_u32 v156, v167, 4, v156
    v_mfma_f32_32x32x16_bf16 v[76:91], v[240:243], v[188:191], v[76:91]
    ds_read_b64_tr_b16 v[224:225], v45 offset:22528
    ds_read_b64_tr_b16 v[226:227], v45 offset:23552
    v_lshl_add_u32 v156, v53, 3, v156
    v_xor_b32 v157, 16, v156
    v_xor_b32 v158, 32, v156
    v_xor_b32 v159, 48, v156
    v_mfma_f32_32x32x16_bf16 v[60:75], v[244:247], v[192:195], v[60:75]
    ds_read_b64_tr_b16 v[228:229], v44 offset:24576
    ds_read_b64_tr_b16 v[230:231], v44 offset:25600
    v_xor_b32 v160, 64, v156
    v_xor_b32 v161, 80, v156
    v_xor_b32 v162, 96, v156
    v_xor_b32 v163, 112, v156
    v_mfma_f32_32x32x16_bf16 v[76:91], v[248:251], v[192:195], v[76:91]
    ds_read_b64_tr_b16 v[232:233], v45 offset:24576
    ds_read_b64_tr_b16 v[234:235], v45 offset:25600
    v_add_u32 v156, s70, v156
    v_add_u32 v157, s70, v157
    v_add_u32 v158, s70, v158
    v_add_u32 v159, s70, v159
    s_waitcnt lgkmcnt(8)
    v_mfma_f32_32x32x16_bf16 v[60:75], v[20:23], v[196:199], v[60:75]
    ds_read_b64_tr_b16 v[236:237], v44 offset:26624
    ds_read_b64_tr_b16 v[238:239], v44 offset:27648
    v_add_u32 v160, s70, v160
    v_add_u32 v161, s70, v161
    v_add_u32 v162, s70, v162
    v_add_u32 v163, s70, v163
    v_mfma_f32_32x32x16_bf16 v[76:91], v[24:27], v[196:199], v[76:91]
    ds_read_b64_tr_b16 v[240:241], v45 offset:26624
    ds_read_b64_tr_b16 v[242:243], v45 offset:27648
    v_lshrrev_b32 v166, 3, v0
    v_xor_b32 v164, v167, v166
    v_lshlrev_b32 v164, 4, v164
    v_lshl_add_u32 v164, v166, 7, v164
    v_mfma_f32_32x32x16_bf16 v[60:75], v[28:31], v[200:203], v[60:75]
    ds_read_b64_tr_b16 v[244:245], v44 offset:28672
    ds_read_b64_tr_b16 v[246:247], v44 offset:29696
    v_add_u32 v164, s70, v164
    v_lshlrev_b32 v165, 11, v166
    v_lshl_add_u32 v165, v167, 4, v165
    v_mfma_f32_32x32x16_bf16 v[76:91], v[32:35], v[200:203], v[76:91]
    ds_read_b64_tr_b16 v[248:249], v45 offset:28672
    ds_read_b64_tr_b16 v[250:251], v45 offset:29696
    s_cmp_eq_u32 s69, 1
    s_cbranch_scc1 L_haveb
    s_mov_b32 s55, 0
L_apb:
    v_mov_b32 v37, 0
    s_mov_b64 exec, 1
    buffer_atomic_add v37, v15, s[16:19], s64 offen sc0
    s_mov_b64 exec, -1
L_apcb:
    s_add_u32 s55, s55, 1
    s_waitcnt vmcnt(0)
    v_readfirstlane_b32 s54, v37
    s_nop 0
    s_cmp_ge_u32 s54, 64
    s_cbranch_scc1 L_apdb
    s_cmp_gt_u32 s55, 0x20000
    s_cbranch_scc1 L_apdb
    s_sleep 2
    s_branch L_apb
L_apdb:
    s_mov_b32 m0, s70
    s_mov_b32 s45, s66
    buffer_load_dwordx4 v55, s[16:19], s45 offen offset:0 sc1 lds
    s_add_u32 s45, s45, 64512
    buffer_load_dwordx4 v55, s[16:19], s45 offen offset:1024 sc1 lds
    s_add_u32 s45, s45, 64512
    buffer_load_dwordx4 v55, s[16:19], s45 offen offset:2048 sc1 lds
    s_add_u32 s45, s45, 64512
    buffer_load_dwordx4 v55, s[16:19], s45 offen offset:3072 sc1 lds
    s_add_u32 s45, s45, 64512
L_haveb:
    s_waitcnt vmcnt(0)
    ds_read_b64_tr_b16 v[124:125], v56 offset:0
    ds_read_b64_tr_b16 v[126:127], v56 offset:512
    ds_read_b64_tr_b16 v[128:129], v56 offset:1024
    ds_read_b64_tr_b16 v[130:131], v56 offset:1536
    ds_read_b64_tr_b16 v[132:133], v56 offset:2048
    ds_read_b64_tr_b16 v[134:135], v56 offset:2560
    ds_read_b64_tr_b16 v[136:137], v56 offset:3072
    ds_read_b64_tr_b16 v[138:139], v56 offset:3584
    v_sub_f32 v48, 1.0, v46
    v_cvt_pk_bf16_f32 v48, v48, v48
    v_lshlrev_b32 v48, 16, v48
    s_waitcnt lgkmcnt(15)
    v_mfma_f32_32x32x16_bf16 v[60:75], v[220:223], v[204:207], v[60:75]
    v_mfma_f32_32x32x16_bf16 v[76:91], v[224:227], v[204:207], v[76:91]
    v_mfma_f32_32x32x16_bf16 v[60:75], v[228:231], v[208:211], v[60:75]
    v_mfma_f32_32x32x16_bf16 v[76:91], v[232:235], v[208:211], v[76:91]
    s_waitcnt lgkmcnt(0)
    v_mfma_f32_32x32x16_bf16 v[60:75], v[236:239], v[212:215], v[60:75]
    v_lshlrev_b32 v92, 16, v124
    v_and_b32 v93, 0xffff0000, v124
    v_mul_f32 v92, v92, v48
    v_mul_f32 v93, v93, v48
    v_lshlrev_b32 v94, 16, v125
    v_and_b32 v95, 0xffff0000, v125
    v_mul_f32 v94, v94, v48
    v_mul_f32 v95, v95, v48
    v_mfma_f32_32x32x16_bf16 v[76:91], v[240:243], v[212:215], v[76:91]
    v_lshlrev_b32 v96, 16, v126
    v_and_b32 v97, 0xffff0000, v126
    v_mul_f32 v96, v96, v48
    v_mul_f32 v97, v97, v48
    v_lshlrev_b32 v98, 16, v127
    v_and_b32 v99, 0xffff0000, v127
    v_mul_f32 v98, v98, v48
    v_mul_f32 v99, v99, v48
    v_mfma_f32_32x32x16_bf16 v[60:75], v[244:247], v[216:219], v[60:75]
    v_lshlrev_b32 v100, 16, v128
    v_and_b32 v101, 0xffff0000, v128
    v_mul_f32 v100, v100, v48
    v_mul_f32 v101, v101, v48
    v_lshlrev_b32 v102, 16, v129
    v_and_b32 v103, 0xffff0000, v129
    v_mul_f32 v102, v102, v48
    v_mul_f32 v103, v103, v48
    v_mfma_f32_32x32x16_bf16 v[76:91], v[248:251], v[216:219], v[76:91]
    v_lshlrev_b32 v104, 16, v130
    v_and_b32 v105, 0xffff0000, v130
    v_mul_f32 v104, v104, v48
    v_mul_f32 v105, v105, v48
    v_lshlrev_b32 v106, 16, v131
    v_and_b32 v107, 0xffff0000, v131
    v_mul_f32 v106, v106, v48
    v_mul_f32 v107, v107, v48
    v_lshlrev_b32 v108, 16, v132
    v_and_b32 v109, 0xffff0000, v132
    v_mul_f32 v108, v108, v48
    v_mul_f32 v109, v109, v48
    v_lshlrev_b32 v110, 16, v133
    v_and_b32 v111, 0xffff0000, v133
    v_mul_f32 v110, v110, v48
    v_mul_f32 v111, v111, v48
    v_lshlrev_b32 v112, 16, v134
    v_and_b32 v113, 0xffff0000, v134
    v_mul_f32 v112, v112, v48
    v_mul_f32 v113, v113, v48
    v_lshlrev_b32 v114, 16, v135
    v_and_b32 v115, 0xffff0000, v135
    v_mul_f32 v114, v114, v48
    v_mul_f32 v115, v115, v48
    v_lshlrev_b32 v116, 16, v136
    v_and_b32 v117, 0xffff0000, v136
    v_mul_f32 v116, v116, v48
    v_mul_f32 v117, v117, v48
    v_lshlrev_b32 v118, 16, v137
    v_and_b32 v119, 0xffff0000, v137
    v_mul_f32 v118, v118, v48
    v_mul_f32 v119, v119, v48
    v_lshlrev_b32 v120, 16, v138
    v_and_b32 v121, 0xffff0000, v138
    v_mul_f32 v120, v120, v48
    v_mul_f32 v121, v121, v48
    v_lshlrev_b32 v122, 16, v139
    v_and_b32 v123, 0xffff0000, v139
    v_mul_f32 v122, v122, v48
    v_mul_f32 v123, v123, v48
    v_fmac_f32 v92, v60, v46
    v_fmac_f32 v93, v61, v46
    v_cvt_pk_bf16_f32 v124, v92, v93
    v_fmac_f32 v94, v62, v46
    v_fmac_f32 v95, v63, v46
    v_cvt_pk_bf16_f32 v125, v94, v95
    ds_write_b64 v156, v[124:125]
    v_fmac_f32 v96, v64, v46
    v_fmac_f32 v97, v65, v46
    v_cvt_pk_bf16_f32 v126, v96, v97
    v_fmac_f32 v98, v66, v46
    v_fmac_f32 v99, v67, v46
    v_cvt_pk_bf16_f32 v127, v98, v99
    ds_write_b64 v157, v[126:127]
    v_fmac_f32 v100, v68, v46
    v_fmac_f32 v101, v69, v46
    v_cvt_pk_bf16_f32 v128, v100, v101
    v_fmac_f32 v102, v70, v46
    v_fmac_f32 v103, v71, v46
    v_cvt_pk_bf16_f32 v129, v102, v103
    ds_write_b64 v158, v[128:129]
    v_fmac_f32 v104, v72, v46
    v_fmac_f32 v105, v73, v46
    v_cvt_pk_bf16_f32 v130, v104, v105
    v_fmac_f32 v106, v74, v46
    v_fmac_f32 v107, v75, v46
    v_cvt_pk_bf16_f32 v131, v106, v107
    ds_write_b64 v159, v[130:131]
    v_fmac_f32 v108, v76, v46
    v_fmac_f32 v109, v77, v46
    v_cvt_pk_bf16_f32 v132, v108, v109
    v_fmac_f32 v110, v78, v46
    v_fmac_f32 v111, v79, v46
    v_cvt_pk_bf16_f32 v133, v110, v111
    ds_write_b64 v160, v[132:133]
    v_fmac_f32 v112, v80, v46
    v_fmac_f32 v113, v81, v46
    v_cvt_pk_bf16_f32 v134, v112, v113
    v_fmac_f32 v114, v82, v46
    v_fmac_f32 v115, v83, v46
    v_cvt_pk_bf16_f32 v135, v114, v115
    ds_write_b64 v161, v[134:135]
    v_fmac_f32 v116, v84, v46
    v_fmac_f32 v117, v85, v46
    v_cvt_pk_bf16_f32 v136, v116, v117
    v_fmac_f32 v118, v86, v46
    v_fmac_f32 v119, v87, v46
    v_cvt_pk_bf16_f32 v137, v118, v119
    ds_write_b64 v162, v[136:137]
    v_fmac_f32 v120, v88, v46
    v_fmac_f32 v121, v89, v46
    v_cvt_pk_bf16_f32 v138, v120, v121
    v_fmac_f32 v122, v90, v46
    v_fmac_f32 v123, v91, v46
    v_cvt_pk_bf16_f32 v139, v122, v123
    ds_write_b64 v163, v[138:139]
    ds_read_b128 v[140:143], v164 offset:0
    ds_read_b128 v[144:147], v164 offset:1024
    ds_read_b128 v[148:151], v164 offset:2048
    ds_read_b128 v[152:155], v164 offset:3072
    s_waitcnt lgkmcnt(3)
    buffer_store_dwordx4 v[140:143], v165, s[76:79], s68 offen
    s_add_u32 s68, s68, 16384
    s_waitcnt lgkmcnt(2)
    buffer_store_dwordx4 v[144:147], v165, s[76:79], s68 offen
    s_add_u32 s68, s68, 16384
    s_waitcnt lgkmcnt(1)
    buffer_store_dwordx4 v[148:151], v165, s[76:79], s68 offen
    s_add_u32 s68, s68, 16384
    s_waitcnt lgkmcnt(0)
    buffer_store_dwordx4 v[152:155], v165, s[76:79], s68 offen
    s_add_u32 s68, s68, 16384
    s_endpgm
L_h:
    s_load_dwordx8 s[76:83], s[0:1], 32
    s_load_dwordx4 s[84:87], s[0:1], 64
    s_load_dwordx2 s[22:23], s[0:1], 80
    s_load_dwordx2 s[50:51], s[0:1], 96
    s_load_dwordx2 s[24:25], s[0:1], 16
    s_sub_u32 s37, s31, 4
    s_lshl_b32 s38, s2, 2
    s_add_u32 s38, s38, s37
    s_lshl_b32 s39, s37, 13
    s_add_u32 s39, s39, 122880
    v_lshlrev_b32 v14, 4, v0
    v_mov_b32 v20, 0
    s_lshl_b32 s88, s35, 7
    s_lshl_b32 s46, s36, 3
    s_add_u32 s88, s88, s46
    s_lshl_b32 s46, s37, 1
    s_add_u32 s88, s88, s46
    s_lshl_b32 s90, s88, 11
    v_mov_b32 v5, 0x7ffffff0
    s_and_b32 s46, s38, 1
    s_mul_i32 s46, s46, 12
    v_add_u32 v6, s46, v0
    v_lshrrev_b32 v24, 3, v6
    v_lshlrev_b32 v24, 11, v24
    v_and_b32 v6, 7, v6
    v_lshl_add_u32 v24, v6, 7, v24
    v_cmp_gt_u32 vcc, 12, v0
    s_bfe_u32 s46, s38, 0x80001
    s_mul_i32 s44, s46, 6144
    s_lshr_b32 s91, s38, 9
    s_lshl_b32 s46, s91, 10
    s_add_u32 s44, s44, s46
    s_lshl_b32 s91, s91, 1
    v_cndmask_b32 v24, v5, v24, vcc
    v_lshrrev_b32 v25, 2, v0
    v_lshlrev_b32 v25, 10, v25
    v_and_b32 v6, 3, v0
    v_lshl_add_u32 v25, v6, 7, v25
    v_cmp_gt_u32 vcc, 16, v0
    s_nop 1
    v_cndmask_b32 v25, v5, v25, vcc
    s_waitcnt lgkmcnt(0)
    s_mov_b32 s8, s4
    s_mov_b32 s9, s5
    s_mov_b32 s10, 0x400000
    s_mov_b32 s11, 0x00020000
    s_mov_b32 s12, s6
    s_mov_b32 s13, s7
    s_mov_b32 s14, 0x600000
    s_mov_b32 s15, 0x00020000
    buffer_load_dword v18, v25, s[8:11], s90 offen offset:0
    s_add_u32 s45, s91, 0
    s_and_b32 s45, s45, 3
    s_mul_i32 s45, s45, 1572864
    s_add_u32 s45, s45, s44
    buffer_load_dword v18, v24, s[12:15], s45 offen
    s_barrier
    s_mov_b32 s16, s20
    s_mov_b32 s17, s21
    s_mov_b32 s18, 0x10000000
    s_mov_b32 s19, 0x00020000
    s_mov_b32 s52, s50
    s_mov_b32 s53, s51
    s_mov_b32 s54, 0x100
    s_mov_b32 s55, 0x00020000
    v_lshlrev_b32 v27, 2, v0
    v_mov_b32 v21, 0
    v_mov_b32 v22, 0
    v_mov_b32 v23, 0
    v_lshrrev_b32 v2, 4, v0
    v_bfe_u32 v3, v0, 2, 2
    v_lshl_add_u32 v3, v2, 3, v3
    v_lshlrev_b32 v3, 7, v3
    v_bfe_u32 v4, v0, 1, 1
    v_bfe_u32 v5, v0, 3, 1
    v_xor_b32 v4, v4, v5
    v_bfe_u32 v5, v0, 4, 1
    v_lshl_add_u32 v4, v5, 2, v4
    v_lshl_add_u32 v3, v4, 4, v3
    v_and_b32 v4, 1, v0
    v_lshl_add_u32 v3, v4, 3, v3
    s_and_b32 s96, s36, 7
    s_mov_b32 s46, 0
    s_mul_hi_u32 s47, s96, 0x55555556
    s_mul_i32 s47, s47, 3
    s_sub_u32 s47, s96, s47
    s_mul_i32 s47, s47, 40960
    s_add_u32 s46, s46, s47
    s_lshl_b32 s47, s37, 5
    v_xor_b32 v36, s47, v3
    v_xor_b32 v37, 32, v36
    v_add_u32 v36, s46, v36
    v_add_u32 v37, s46, v37
    v_and_b32 v3, 15, v0
    v_mul_u32_u24 v38, 272, v3
    v_lshl_add_u32 v38, v2, 4, v38
    v_add_u32 v38, s39, v38
    v_mul_u32_u24 v39, 272, v2
    v_lshl_add_u32 v39, v3, 4, v39
    v_add_u32 v39, s39, v39
    v_lshlrev_b32 v56, 12, v2
    v_lshl_add_u32 v56, v3, 4, v56
    s_lshl_b32 s46, s36, 18
    s_lshl_b32 s47, s35, 8
    s_add_u32 s46, s46, s47
    s_lshl_b32 s47, s37, 16
    s_add_u32 s46, s46, s47
    s_add_u32 s89, s46, 4194304
    s_cmp_eq_u32 s35, s36
    s_cselect_b32 s92, 2, 99
    s_cmp_eq_u32 s92, s37
    s_cselect_b32 s92, 1, 0
    s_lshl_b32 s97, s35, 2
    s_add_u32 s97, s97, s37
    s_lshl_b32 s97, s97, 16
    s_lshl_b32 s46, s36, 12
    s_add_u32 s97, s97, s46
    s_cmp_lg_u32 s96, 0
    s_cbranch_scc1 L_tr0
    ds_read_b64_tr_b16 v[40:41], v36 offset:0
    ds_read_b64_tr_b16 v[42:43], v37 offset:512
    ds_read_b64_tr_b16 v[44:45], v36 offset:4096
    ds_read_b64_tr_b16 v[46:47], v37 offset:4608
    ds_read_b64_tr_b16 v[48:49], v36 offset:8192
    ds_read_b64_tr_b16 v[50:51], v37 offset:8704
    ds_read_b64_tr_b16 v[52:53], v36 offset:12288
    ds_read_b64_tr_b16 v[54:55], v37 offset:12800
    s_waitcnt lgkmcnt(0)
    ds_write_b128 v38, v[40:43] offset:0
    ds_write_b128 v38, v[44:47] offset:64
    ds_write_b128 v38, v[48:51] offset:128
    ds_write_b128 v38, v[52:55] offset:192
L_tr0:
    s_cmp_lg_u32 s92, 1
    s_cbranch_scc1 L_h3
    s_lshl_b32 s47, s36, 13
    s_add_u32 s47, s47, 12582912
    s_add_u32 s49, s47, 4096
    buffer_store_dwordx4 v[20:23], v14, s[16:19], s47 offen offset:0 sc1
    buffer_store_dwordx4 v[20:23], v14, s[16:19], s49 offen offset:0 sc1
    buffer_store_dwordx4 v[20:23], v14, s[16:19], s47 offen offset:1024 sc1
    buffer_store_dwordx4 v[20:23], v14, s[16:19], s49 offen offset:1024 sc1
    buffer_store_dwordx4 v[20:23], v14, s[16:19], s47 offen offset:2048 sc1
    buffer_store_dwordx4 v[20:23], v14, s[16:19], s49 offen offset:2048 sc1
    buffer_store_dwordx4 v[20:23], v14, s[16:19], s47 offen offset:3072 sc1
    buffer_store_dwordx4 v[20:23], v14, s[16:19], s49 offen offset:3072 sc1
    s_lshl_b32 s47, s36, 8
    s_add_u32 s47, s47, 12713984
    s_mul_i32 s49, s36, 3072
    s_add_u32 s49, s49, 12845056
    s_mov_b64 exec, 0xffff
    buffer_store_dwordx4 v[20:23], v14, s[16:19], s47 offen sc1
    s_mov_b64 exec, -1
    buffer_store_dwordx4 v[20:23], v14, s[16:19], s49 offen sc1
    buffer_store_dwordx4 v[20:23], v14, s[16:19], s49 offen offset:1024 sc1
    buffer_store_dwordx4 v[20:23], v14, s[16:19], s49 offen offset:2048 sc1
L_h3:
    s_barrier
    s_cmp_lg_u32 s96, 1
    s_cbranch_scc1 L_tr1
    ds_read_b64_tr_b16 v[40:41], v36 offset:0
    ds_read_b64_tr_b16 v[42:43], v37 offset:512
    ds_read_b64_tr_b16 v[44:45], v36 offset:4096
    ds_read_b64_tr_b16 v[46:47], v37 offset:4608
    ds_read_b64_tr_b16 v[48:49], v36 offset:8192
    ds_read_b64_tr_b16 v[50:51], v37 offset:8704
    ds_read_b64_tr_b16 v[52:53], v36 offset:12288
    ds_read_b64_tr_b16 v[54:55], v37 offset:12800
    s_waitcnt lgkmcnt(0)
    ds_write_b128 v38, v[40:43] offset:0
    ds_write_b128 v38, v[44:47] offset:64
    ds_write_b128 v38, v[48:51] offset:128
    ds_write_b128 v38, v[52:55] offset:192
L_tr1:
    s_cmp_lg_u32 s96, 0
    s_cbranch_scc1 L_ts1
    ds_read_b128 v[40:43], v39 offset:0
    ds_read_b128 v[44:47], v39 offset:1088
    ds_read_b128 v[48:51], v39 offset:2176
    ds_read_b128 v[52:55], v39 offset:3264
    s_waitcnt lgkmcnt(3)
    buffer_store_dwordx4 v[40:43], v56, s[16:19], s89 offen sc1
    s_add_u32 s89, s89, 16384
    s_waitcnt lgkmcnt(2)
    buffer_store_dwordx4 v[44:47], v56, s[16:19], s89 offen sc1
    s_add_u32 s89, s89, 16384
    s_waitcnt lgkmcnt(1)
    buffer_store_dwordx4 v[48:51], v56, s[16:19], s89 offen sc1
    s_add_u32 s89, s89, 16384
    s_waitcnt lgkmcnt(0)
    buffer_store_dwordx4 v[52:55], v56, s[16:19], s89 offen sc1
    s_add_u32 s89, s89, 16384
L_ts1:
    buffer_load_dword v18, v25, s[8:11], s90 offen offset:512
    s_add_u32 s45, s91, 1
    s_and_b32 s45, s45, 3
    s_mul_i32 s45, s45, 1572864
    s_add_u32 s45, s45, s44
    buffer_load_dword v18, v24, s[12:15], s45 offen
    v_lshrrev_b32 v16, 5, v0
    v_bfe_u32 v3, v0, 1, 2
    v_lshlrev_b32 v3, 4, v3
    v_lshl_add_u32 v57, v0, 6, v3
    v_add_u32 v57, s39, v57
    v_xor_b32 v58, 16, v57
    v_xor_b32 v59, 32, v57
    v_xor_b32 v60, 48, v57
    v_bfe_u32 v3, v0, 2, 2
    v_lshl_add_u32 v4, v16, 3, v3
    v_bfe_u32 v5, v0, 4, 1
    v_bfe_u32 v6, v0, 1, 1
    v_lshl_add_u32 v5, v5, 1, v6
    v_bfe_u32 v6, v0, 3, 1
    v_xor_b32 v5, v5, v6
    v_lshlrev_b32 v5, 4, v5
    v_lshl_add_u32 v5, v4, 6, v5
    v_and_b32 v6, 1, v0
    v_lshl_add_u32 v5, v6, 3, v5
    v_add_u32 v61, s39, v5
    v_xor_b32 v62, 32, v61
    s_mov_b32 s93, 0x05040100
    s_getpc_b64 s[26:27]
L_pc:
    s_sub_u32 s26, s26, L_pc-gated_mix__linear_attn_block__ssm_conv_s4d__prompt_kernel
    s_subb_u32 s27, s27, 0
    s_lshr_b32 s28, s2, 3
    s_lshl_b32 s28, s28, 2
    s_add_u32 s28, s28, s37
    s_mul_i32 s28, s28, 3
    v_add_u32 v6, s28, v0
    v_lshlrev_b32 v6, 7, v6
    v_min_u32 v6, L_end-gated_mix__linear_attn_block__ssm_conv_s4d__prompt_kernel, v6
    v_mov_b32 v5, s27
    v_add_co_u32 v4, vcc, s26, v6
    s_nop 1
    v_addc_co_u32 v5, vcc, 0, v5, vcc
    s_mov_b64 exec, 7
    global_load_dword v18, v[4:5], off
    s_mov_b64 exec, -1
    s_barrier
    s_cmp_lg_u32 s96, 2
    s_cbranch_scc1 L_tr2
    ds_read_b64_tr_b16 v[40:41], v36 offset:0
    ds_read_b64_tr_b16 v[42:43], v37 offset:512
    ds_read_b64_tr_b16 v[44:45], v36 offset:4096
    ds_read_b64_tr_b16 v[46:47], v37 offset:4608
    ds_read_b64_tr_b16 v[48:49], v36 offset:8192
    ds_read_b64_tr_b16 v[50:51], v37 offset:8704
    ds_read_b64_tr_b16 v[52:53], v36 offset:12288
    ds_read_b64_tr_b16 v[54:55], v37 offset:12800
    s_waitcnt lgkmcnt(0)
    ds_write_b128 v38, v[40:43] offset:0
    ds_write_b128 v38, v[44:47] offset:64
    ds_write_b128 v38, v[48:51] offset:128
    ds_write_b128 v38, v[52:55] offset:192
L_tr2:
    s_cmp_lg_u32 s96, 1
    s_cbranch_scc1 L_ts2
    ds_read_b128 v[40:43], v39 offset:0
    ds_read_b128 v[44:47], v39 offset:1088
    ds_read_b128 v[48:51], v39 offset:2176
    ds_read_b128 v[52:55], v39 offset:3264
    s_waitcnt lgkmcnt(3)
    buffer_store_dwordx4 v[40:43], v56, s[16:19], s89 offen sc1
    s_add_u32 s89, s89, 16384
    s_waitcnt lgkmcnt(2)
    buffer_store_dwordx4 v[44:47], v56, s[16:19], s89 offen sc1
    s_add_u32 s89, s89, 16384
    s_waitcnt lgkmcnt(1)
    buffer_store_dwordx4 v[48:51], v56, s[16:19], s89 offen sc1
    s_add_u32 s89, s89, 16384
    s_waitcnt lgkmcnt(0)
    buffer_store_dwordx4 v[52:55], v56, s[16:19], s89 offen sc1
    s_add_u32 s89, s89, 16384
L_ts2:
    v_mov_b32 v2, 163584
    s_mov_b64 exec, 1
    ds_write_b128 v2, v[20:23]
    ds_write_b128 v2, v[20:23] offset:16
    s_mov_b64 exec, -1
    s_waitcnt lgkmcnt(0)
    s_barrier
    s_cmp_lg_u32 s96, 3
    s_cbranch_scc1 L_tr3
    ds_read_b64_tr_b16 v[40:41], v36 offset:0
    ds_read_b64_tr_b16 v[42:43], v37 offset:512
    ds_read_b64_tr_b16 v[44:45], v36 offset:4096
    ds_read_b64_tr_b16 v[46:47], v37 offset:4608
    ds_read_b64_tr_b16 v[48:49], v36 offset:8192
    ds_read_b64_tr_b16 v[50:51], v37 offset:8704
    ds_read_b64_tr_b16 v[52:53], v36 offset:12288
    ds_read_b64_tr_b16 v[54:55], v37 offset:12800
    s_waitcnt lgkmcnt(0)
    ds_write_b128 v38, v[40:43] offset:0
    ds_write_b128 v38, v[44:47] offset:64
    ds_write_b128 v38, v[48:51] offset:128
    ds_write_b128 v38, v[52:55] offset:192
L_tr3:
    s_cmp_lg_u32 s96, 2
    s_cbranch_scc1 L_ts3
    ds_read_b128 v[40:43], v39 offset:0
    ds_read_b128 v[44:47], v39 offset:1088
    ds_read_b128 v[48:51], v39 offset:2176
    ds_read_b128 v[52:55], v39 offset:3264
    s_waitcnt lgkmcnt(3)
    buffer_store_dwordx4 v[40:43], v56, s[16:19], s89 offen sc1
    s_add_u32 s89, s89, 16384
    s_waitcnt lgkmcnt(2)
    buffer_store_dwordx4 v[44:47], v56, s[16:19], s89 offen sc1
    s_add_u32 s89, s89, 16384
    s_waitcnt lgkmcnt(1)
    buffer_store_dwordx4 v[48:51], v56, s[16:19], s89 offen sc1
    s_add_u32 s89, s89, 16384
    s_waitcnt lgkmcnt(0)
    buffer_store_dwordx4 v[52:55], v56, s[16:19], s89 offen sc1
    s_add_u32 s89, s89, 16384
L_ts3:
    s_barrier
    s_cmp_lg_u32 s96, 4
    s_cbranch_scc1 L_tr4
    ds_read_b64_tr_b16 v[40:41], v36 offset:0
    ds_read_b64_tr_b16 v[42:43], v37 offset:512
    ds_read_b64_tr_b16 v[44:45], v36 offset:4096
    ds_read_b64_tr_b16 v[46:47], v37 offset:4608
    ds_read_b64_tr_b16 v[48:49], v36 offset:8192
    ds_read_b64_tr_b16 v[50:51], v37 offset:8704
    ds_read_b64_tr_b16 v[52:53], v36 offset:12288
    ds_read_b64_tr_b16 v[54:55], v37 offset:12800
    s_waitcnt lgkmcnt(0)
    ds_write_b128 v38, v[40:43] offset:0
    ds_write_b128 v38, v[44:47] offset:64
    ds_write_b128 v38, v[48:51] offset:128
    ds_write_b128 v38, v[52:55] offset:192
L_tr4:
    s_cmp_lg_u32 s96, 3
    s_cbranch_scc1 L_ts4
    ds_read_b128 v[40:43], v39 offset:0
    ds_read_b128 v[44:47], v39 offset:1088
    ds_read_b128 v[48:51], v39 offset:2176
    ds_read_b128 v[52:55], v39 offset:3264
    s_waitcnt lgkmcnt(3)
    buffer_store_dwordx4 v[40:43], v56, s[16:19], s89 offen sc1
    s_add_u32 s89, s89, 16384
    s_waitcnt lgkmcnt(2)
    buffer_store_dwordx4 v[44:47], v56, s[16:19], s89 offen sc1
    s_add_u32 s89, s89, 16384
    s_waitcnt lgkmcnt(1)
    buffer_store_dwordx4 v[48:51], v56, s[16:19], s89 offen sc1
    s_add_u32 s89, s89, 16384
    s_waitcnt lgkmcnt(0)
    buffer_store_dwordx4 v[52:55], v56, s[16:19], s89 offen sc1
    s_add_u32 s89, s89, 16384
L_ts4:
    s_add_u32 s45, s91, 2
    s_and_b32 s45, s45, 3
    s_mul_i32 s45, s45, 1572864
    s_add_u32 s45, s45, s44
    buffer_load_dword v18, v24, s[12:15], s45 offen
    s_mov_b32 s56, s76
    s_mov_b32 s57, s77
    s_mov_b32 s58, 0x40000
    s_mov_b32 s59, 0x00020000
    s_lshl_b32 s94, s38, 8
    buffer_load_dword v28, v27, s[56:59], s94 offen
    s_mov_b32 s56, s78
    s_mov_b32 s57, s79
    s_mov_b32 s58, 0x40000
    s_mov_b32 s59, 0x00020000
    s_lshl_b32 s94, s38, 8
    buffer_load_dword v30, v27, s[56:59], s94 offen
    s_mov_b32 s56, s80
    s_mov_b32 s57, s81
    s_mov_b32 s58, 0x40000
    s_mov_b32 s59, 0x00020000
    s_lshl_b32 s94, s38, 8
    buffer_load_dword v32, v27, s[56:59], s94 offen
    s_mov_b32 s56, s82
    s_mov_b32 s57, s83
    s_mov_b32 s58, 0x40000
    s_mov_b32 s59, 0x00020000
    s_lshl_b32 s94, s38, 8
    buffer_load_dword v34, v27, s[56:59], s94 offen
    s_mov_b32 s56, s84
    s_mov_b32 s57, s85
    s_mov_b32 s58, 0x800
    s_mov_b32 s59, 0x00020000
    s_lshl_b32 s94, s38, 1
    buffer_load_ushort v17, v20, s[56:59], s94 offen
    s_mov_b32 s56, s86
    s_mov_b32 s57, s87
    s_mov_b32 s58, 0x800
    s_mov_b32 s59, 0x00020000
    s_lshl_b32 s94, s38, 1
    buffer_load_ushort v15, v20, s[56:59], s94 offen
    s_barrier
    s_cmp_lg_u32 s96, 5
    s_cbranch_scc1 L_tr5
    ds_read_b64_tr_b16 v[40:41], v36 offset:0
    ds_read_b64_tr_b16 v[42:43], v37 offset:512
    ds_read_b64_tr_b16 v[44:45], v36 offset:4096
    ds_read_b64_tr_b16 v[46:47], v37 offset:4608
    ds_read_b64_tr_b16 v[48:49], v36 offset:8192
    ds_read_b64_tr_b16 v[50:51], v37 offset:8704
    ds_read_b64_tr_b16 v[52:53], v36 offset:12288
    ds_read_b64_tr_b16 v[54:55], v37 offset:12800
    s_waitcnt lgkmcnt(0)
    ds_write_b128 v38, v[40:43] offset:0
    ds_write_b128 v38, v[44:47] offset:64
    ds_write_b128 v38, v[48:51] offset:128
    ds_write_b128 v38, v[52:55] offset:192
L_tr5:
    s_cmp_lg_u32 s96, 4
    s_cbranch_scc1 L_ts5
    ds_read_b128 v[40:43], v39 offset:0
    ds_read_b128 v[44:47], v39 offset:1088
    ds_read_b128 v[48:51], v39 offset:2176
    ds_read_b128 v[52:55], v39 offset:3264
    s_waitcnt lgkmcnt(3)
    buffer_store_dwordx4 v[40:43], v56, s[16:19], s89 offen sc1
    s_add_u32 s89, s89, 16384
    s_waitcnt lgkmcnt(2)
    buffer_store_dwordx4 v[44:47], v56, s[16:19], s89 offen sc1
    s_add_u32 s89, s89, 16384
    s_waitcnt lgkmcnt(1)
    buffer_store_dwordx4 v[48:51], v56, s[16:19], s89 offen sc1
    s_add_u32 s89, s89, 16384
    s_waitcnt lgkmcnt(0)
    buffer_store_dwordx4 v[52:55], v56, s[16:19], s89 offen sc1
    s_add_u32 s89, s89, 16384
L_ts5:
    s_barrier
    s_cmp_lg_u32 s92, 1
    s_cbranch_scc1 L_zp
    s_lshl_b32 s94, s36, 2
    v_mov_b32 v26, 1
    s_waitcnt vmcnt(0)
    s_mov_b64 exec, 1
    buffer_store_dword v26, v20, s[52:55], s94 offen sc1
    s_mov_b64 exec, -1
L_zp:
    s_cmp_lg_u32 s96, 6
    s_cbranch_scc1 L_tr6
    ds_read_b64_tr_b16 v[40:41], v36 offset:0
    ds_read_b64_tr_b16 v[42:43], v37 offset:512
    ds_read_b64_tr_b16 v[44:45], v36 offset:4096
    ds_read_b64_tr_b16 v[46:47], v37 offset:4608
    ds_read_b64_tr_b16 v[48:49], v36 offset:8192
    ds_read_b64_tr_b16 v[50:51], v37 offset:8704
    ds_read_b64_tr_b16 v[52:53], v36 offset:12288
    ds_read_b64_tr_b16 v[54:55], v37 offset:12800
    s_waitcnt lgkmcnt(0)
    ds_write_b128 v38, v[40:43] offset:0
    ds_write_b128 v38, v[44:47] offset:64
    ds_write_b128 v38, v[48:51] offset:128
    ds_write_b128 v38, v[52:55] offset:192
L_tr6:
    s_cmp_lg_u32 s96, 5
    s_cbranch_scc1 L_ts6
    ds_read_b128 v[40:43], v39 offset:0
    ds_read_b128 v[44:47], v39 offset:1088
    ds_read_b128 v[48:51], v39 offset:2176
    ds_read_b128 v[52:55], v39 offset:3264
    s_waitcnt lgkmcnt(3)
    buffer_store_dwordx4 v[40:43], v56, s[16:19], s89 offen sc1
    s_add_u32 s89, s89, 16384
    s_waitcnt lgkmcnt(2)
    buffer_store_dwordx4 v[44:47], v56, s[16:19], s89 offen sc1
    s_add_u32 s89, s89, 16384
    s_waitcnt lgkmcnt(1)
    buffer_store_dwordx4 v[48:51], v56, s[16:19], s89 offen sc1
    s_add_u32 s89, s89, 16384
    s_waitcnt lgkmcnt(0)
    buffer_store_dwordx4 v[52:55], v56, s[16:19], s89 offen sc1
    s_add_u32 s89, s89, 16384
L_ts6:
    s_barrier
    s_sub_u32 s94, s96, 4
    s_cmp_lt_u32 s94, 2
    s_cbranch_scc1 L_wapar
    s_waitcnt vmcnt(0)
L_wapar:
    s_waitcnt vmcnt(4)
    s_cmp_lg_u32 s96, 7
    s_cbranch_scc1 L_tr7
    ds_read_b64_tr_b16 v[40:41], v36 offset:0
    ds_read_b64_tr_b16 v[42:43], v37 offset:512
    ds_read_b64_tr_b16 v[44:45], v36 offset:4096
    ds_read_b64_tr_b16 v[46:47], v37 offset:4608
    ds_read_b64_tr_b16 v[48:49], v36 offset:8192
    ds_read_b64_tr_b16 v[50:51], v37 offset:8704
    ds_read_b64_tr_b16 v[52:53], v36 offset:12288
    ds_read_b64_tr_b16 v[54:55], v37 offset:12800
    s_waitcnt lgkmcnt(0)
    ds_write_b128 v38, v[40:43] offset:0
    ds_write_b128 v38, v[44:47] offset:64
    ds_write_b128 v38, v[48:51] offset:128
    ds_write_b128 v38, v[52:55] offset:192
L_tr7:
    s_cmp_lg_u32 s96, 6
    s_cbranch_scc1 L_ts7
    ds_read_b128 v[40:43], v39 offset:0
    ds_read_b128 v[44:47], v39 offset:1088
    ds_read_b128 v[48:51], v39 offset:2176
    ds_read_b128 v[52:55], v39 offset:3264
    s_waitcnt lgkmcnt(3)
    buffer_store_dwordx4 v[40:43], v56, s[16:19], s89 offen sc1
    s_add_u32 s89, s89, 16384
    s_waitcnt lgkmcnt(2)
    buffer_store_dwordx4 v[44:47], v56, s[16:19], s89 offen sc1
    s_add_u32 s89, s89, 16384
    s_waitcnt lgkmcnt(1)
    buffer_store_dwordx4 v[48:51], v56, s[16:19], s89 offen sc1
    s_add_u32 s89, s89, 16384
    s_waitcnt lgkmcnt(0)
    buffer_store_dwordx4 v[52:55], v56, s[16:19], s89 offen sc1
    s_add_u32 s89, s89, 16384
L_ts7:
    v_lshlrev_b32 v17, 16, v17
    v_and_b32 v29, 0xffff0000, v28
    v_lshlrev_b32 v28, 16, v28
    v_and_b32 v31, 0xffff0000, v30
    v_lshlrev_b32 v30, 16, v30
    v_and_b32 v33, 0xffff0000, v32
    v_lshlrev_b32 v32, 16, v32
    v_and_b32 v35, 0xffff0000, v34
    v_lshlrev_b32 v34, 16, v34
    v_mul_f32 v17, 0x3fb8aa3b, v17
    v_max_f32 v2, |v32|, |v33|
    v_exp_f32 v17, v17
    v_max3_f32 v2, |v34|, |v35|, v2
    v_mul_f32 v28, 0x3fb8aa3b, v28
    v_mul_f32 v29, 0x3fb8aa3b, v29
    v_max_f32_dpp v2, v2, v2 quad_perm:[1,0,3,2] row_mask:0xf bank_mask:0xf
    v_exp_f32 v28, v28
    v_exp_f32 v29, v29
    v_max_f32_dpp v2, v2, v2 quad_perm:[2,3,0,1] row_mask:0xf bank_mask:0xf
    v_cvt_pk_bf16_f32 v17, v17, v17
    v_lshlrev_b32 v17, 16, v17
    v_max_f32_dpp v2, v2, v2 row_half_mirror row_mask:0xf bank_mask:0xf
    v_cvt_pk_bf16_f32 v28, v28, v29
    v_and_b32 v29, 0xffff0000, v28
    v_max_f32_dpp v2, v2, v2 row_mirror row_mask:0xf bank_mask:0xf
    v_lshlrev_b32 v28, 16, v28
    v_mul_f32 v28, v28, v17
    v_readlane_b32 s46, v2, 0
    v_readlane_b32 s47, v2, 16
    v_readlane_b32 s48, v2, 32
    v_readlane_b32 s49, v2, 48
    v_mul_f32 v29, v29, v17
    v_mul_f32 v30, v30, v17
    v_mul_f32 v31, v31, v17
    s_max_u32 s46, s46, s47
    s_max_u32 s48, s48, s49
    s_max_u32 s46, s46, s48
    s_lshr_b32 s46, s46, 23
    s_min_u32 s46, s46, 252
    s_sub_u32 s73, 253, s46
    s_lshl_b32 s73, s73, 23
    s_add_u32 s72, s46, 2
    s_lshl_b32 s72, s72, 23
    v_mul_f32 v28, 0xbfb8aa3b, v28
    v_mul_f32 v29, 0xbfb8aa3b, v29
    v_mul_f32 v30, 0.15915494, v30
    v_mul_f32 v31, 0.15915494, v31
    v_mov_b32 v187, 0
    v_mov_b32 v199, 0
    v_mul_f32 v2, 0x41000000, v28
    v_exp_f32 v4, v28
    v_mul_f32 v6, 0x43800000, v28
    v_mul_f32 v3, 0x41000000, v30
    v_fract_f32 v5, v30
    v_mul_f32 v7, 0x43800000, v30
    v_exp_f32 v2, v2
    v_cos_f32 v80, v5
    v_exp_f32 v6, v6
    v_fract_f32 v3, v3
    v_sin_f32 v81, v5
    v_fract_f32 v7, v7
    s_barrier
    s_cmp_lg_u32 s96, 7
    s_cbranch_scc1 L_ts8
    ds_read_b128 v[40:43], v39 offset:0
    ds_read_b128 v[44:47], v39 offset:1088
    ds_read_b128 v[48:51], v39 offset:2176
    ds_read_b128 v[52:55], v39 offset:3264
    s_waitcnt lgkmcnt(3)
    buffer_store_dwordx4 v[40:43], v56, s[16:19], s89 offen sc1
    s_add_u32 s89, s89, 16384
    s_waitcnt lgkmcnt(2)
    buffer_store_dwordx4 v[44:47], v56, s[16:19], s89 offen sc1
    s_add_u32 s89, s89, 16384
    s_waitcnt lgkmcnt(1)
    buffer_store_dwordx4 v[48:51], v56, s[16:19], s89 offen sc1
    s_add_u32 s89, s89, 16384
    s_waitcnt lgkmcnt(0)
    buffer_store_dwordx4 v[52:55], v56, s[16:19], s89 offen sc1
    s_add_u32 s89, s89, 16384
L_ts8:
    s_add_u32 s45, s91, 3
    s_and_b32 s45, s45, 3
    s_mul_i32 s45, s45, 1572864
    s_add_u32 s45, s45, s44
    buffer_load_dword v18, v24, s[12:15], s45 offen
    v_cos_f32 v92, v3
    v_mul_f32 v80, v80, v4
    v_cos_f32 v88, v7
    v_sin_f32 v93, v3
    v_mul_f32 v81, v81, v4
    v_sin_f32 v89, v7
    v_mul_f32 v92, v92, v2
    v_mul_f32 v88, v88, v6
    v_mul_f32 v93, v93, v2
    v_mul_f32 v89, v89, v6
    v_mul_f32 v94, s73, v32
    v_mul_f32 v95, -s73, v34
    v_mul_f32 v84, v92, v92
    v_cvt_pk_f16_f32 v98, v80, v81
    v_cvt_pk_f16_f32 v104, v88, v89
    v_mul_f32 v85, v92, v93
    v_mul_f32 v82, v80, v80
    v_mul_f32 v90, v88, v88
    v_fma_f32 v84, -v93, v93, v84
    v_mul_f32 v83, v80, v81
    v_mul_f32 v91, v88, v89
    v_add_f32 v85, v85, v85
    v_fma_f32 v82, -v81, v81, v82
    v_fma_f32 v90, -v89, v89, v90
    v_cvt_pk_f16_f32 v100, v84, v85
    v_add_f32 v83, v83, v83
    v_add_f32 v91, v91, v91
    v_mul_f32 v86, v84, v84
    v_cvt_pk_f16_f32 v99, v82, v83
    v_cvt_pk_f16_f32 v105, v90, v91
    v_mul_f32 v87, v84, v85
    v_mul_f32 v80, v82, v82
    v_mul_f32 v88, v90, v90
    v_fma_f32 v86, -v85, v85, v86
    v_mul_f32 v81, v82, v83
    v_mul_f32 v89, v90, v91
    v_add_f32 v87, v87, v87
    v_fma_f32 v80, -v83, v83, v80
    v_fma_f32 v88, -v91, v91, v88
    v_cvt_pk_f16_f32 v101, v86, v87
    v_add_f32 v81, v81, v81
    v_add_f32 v89, v89, v89
    v_mul_f32 v84, v86, v86
    v_mul_f32 v96, v94, v80
    v_cvt_pk_f16_f32 v106, v88, v89
    v_mul_f32 v85, v86, v87
    v_mul_f32 v97, v95, v80
    v_fma_f32 v84, -v87, v87, v84
    v_fma_f32 v96, v95, v81, v96
    v_add_f32 v85, v85, v85
    v_fma_f32 v97, -v94, v81, v97
    v_cvt_pk_f16_f32 v102, v84, v85
    v_mul_f32 v86, v84, v84
    v_mul_f32 v87, v84, v85
    v_fma_f32 v86, -v85, v85, v86
    v_add_f32 v87, v87, v87
    v_cvt_pk_f16_f32 v103, v86, v87
    v_cvt_pk_f16_f32 v176, v94, v96
    v_cvt_pk_f16_f32 v112, 1.0, v92
    v_cvt_pk_f16_f32 v188, v95, v97
    v_cvt_pk_f16_f32 v128, 0, v93
    v_pk_mul_f16 v177, v176, v99 op_sel_hi:[1,0]
    s_barrier
    v_and_b32 v36, 15, v0
    v_lshlrev_b32 v36, 2, v36
    buffer_load_dword v26, v36, s[52:55], 0 offen sc1
    v_pk_mul_f16 v113, v112, v100 op_sel_hi:[1,0]
    v_pk_mul_f16 v180, v176, v104 op_sel_hi:[1,0]
    v_pk_mul_f16 v129, v128, v100 op_sel_hi:[1,0]
    v_pk_mul_f16 v178, v176, v98 op_sel_hi:[1,0]
    v_pk_fma_f16 v113, v128, v100, v113 op_sel:[0,1,0] op_sel_hi:[1,1,1] neg_lo:[1,0,0] neg_hi:[1,0,0]
    v_pk_mul_f16 v182, v176, v105 op_sel_hi:[1,0]
    v_pk_fma_f16 v129, v112, v100, v129 op_sel:[0,1,0] op_sel_hi:[1,1,1]
    v_pk_mul_f16 v189, v188, v99 op_sel_hi:[1,0]
    v_pk_mul_f16 v114, v112, v101 op_sel_hi:[1,0]
    v_pk_mul_f16 v192, v188, v104 op_sel_hi:[1,0]
    v_pk_mul_f16 v130, v128, v101 op_sel_hi:[1,0]
    v_pk_mul_f16 v190, v188, v98 op_sel_hi:[1,0]
    v_pk_fma_f16 v114, v128, v101, v114 op_sel:[0,1,0] op_sel_hi:[1,1,1] neg_lo:[1,0,0] neg_hi:[1,0,0]
    v_pk_mul_f16 v194, v188, v105 op_sel_hi:[1,0]
    v_pk_fma_f16 v130, v112, v101, v130 op_sel:[0,1,0] op_sel_hi:[1,1,1]
    v_pk_fma_f16 v177, v188, v99, v177 op_sel:[0,1,0] op_sel_hi:[1,1,1]
    v_pk_mul_f16 v115, v113, v101 op_sel_hi:[1,0]
    v_pk_fma_f16 v180, v188, v104, v180 op_sel:[0,1,0] op_sel_hi:[1,1,1]
    v_pk_mul_f16 v131, v129, v101 op_sel_hi:[1,0]
    v_pk_fma_f16 v178, v188, v98, v178 op_sel:[0,1,0] op_sel_hi:[1,1,1]
    v_pk_fma_f16 v115, v129, v101, v115 op_sel:[0,1,0] op_sel_hi:[1,1,1] neg_lo:[1,0,0] neg_hi:[1,0,0]
    v_pk_fma_f16 v182, v188, v105, v182 op_sel:[0,1,0] op_sel_hi:[1,1,1]
    v_pk_fma_f16 v131, v113, v101, v131 op_sel:[0,1,0] op_sel_hi:[1,1,1]
    v_pk_fma_f16 v189, v176, v99, v189 op_sel:[0,1,0] op_sel_hi:[1,1,1] neg_lo:[1,0,0] neg_hi:[1,0,0]
    v_pk_mul_f16 v116, v112, v102 op_sel_hi:[1,0]
    v_pk_fma_f16 v192, v176, v104, v192 op_sel:[0,1,0] op_sel_hi:[1,1,1] neg_lo:[1,0,0] neg_hi:[1,0,0]
    v_pk_mul_f16 v132, v128, v102 op_sel_hi:[1,0]
    v_pk_fma_f16 v190, v176, v98, v190 op_sel:[0,1,0] op_sel_hi:[1,1,1] neg_lo:[1,0,0] neg_hi:[1,0,0]
    v_pk_fma_f16 v116, v128, v102, v116 op_sel:[0,1,0] op_sel_hi:[1,1,1] neg_lo:[1,0,0] neg_hi:[1,0,0]
    v_pk_fma_f16 v194, v176, v105, v194 op_sel:[0,1,0] op_sel_hi:[1,1,1] neg_lo:[1,0,0] neg_hi:[1,0,0]
    v_pk_fma_f16 v132, v112, v102, v132 op_sel:[0,1,0] op_sel_hi:[1,1,1]
    v_perm_b32 v224, v180, v176, s93
    v_pk_mul_f16 v117, v113, v102 op_sel_hi:[1,0]
    v_perm_b32 v225, v192, v188, s93
    v_pk_mul_f16 v133, v129, v102 op_sel_hi:[1,0]
    v_pk_mul_f16 v179, v177, v98 op_sel_hi:[1,0]
    v_pk_fma_f16 v117, v129, v102, v117 op_sel:[0,1,0] op_sel_hi:[1,1,1] neg_lo:[1,0,0] neg_hi:[1,0,0]
    v_pk_mul_f16 v181, v177, v104 op_sel_hi:[1,0]
    v_pk_fma_f16 v133, v113, v102, v133 op_sel:[0,1,0] op_sel_hi:[1,1,1]
    v_pk_mul_f16 v183, v180, v105 op_sel_hi:[1,0]
    v_pk_mul_f16 v118, v114, v102 op_sel_hi:[1,0]
    v_pk_mul_f16 v184, v224, v106 op_sel_hi:[1,0]
    v_pk_mul_f16 v134, v130, v102 op_sel_hi:[1,0]
    v_pk_mul_f16 v191, v189, v98 op_sel_hi:[1,0]
    v_pk_fma_f16 v118, v130, v102, v118 op_sel:[0,1,0] op_sel_hi:[1,1,1] neg_lo:[1,0,0] neg_hi:[1,0,0]
    v_pk_mul_f16 v193, v189, v104 op_sel_hi:[1,0]
    v_pk_fma_f16 v134, v114, v102, v134 op_sel:[0,1,0] op_sel_hi:[1,1,1]
    v_pk_mul_f16 v195, v192, v105 op_sel_hi:[1,0]
    v_pk_mul_f16 v119, v115, v102 op_sel_hi:[1,0]
    v_pk_mul_f16 v196, v225, v106 op_sel_hi:[1,0]
    v_pk_mul_f16 v135, v131, v102 op_sel_hi:[1,0]
    v_pk_fma_f16 v179, v189, v98, v179 op_sel:[0,1,0] op_sel_hi:[1,1,1]
    v_pk_fma_f16 v119, v131, v102, v119 op_sel:[0,1,0] op_sel_hi:[1,1,1] neg_lo:[1,0,0] neg_hi:[1,0,0]
    v_pk_fma_f16 v181, v189, v104, v181 op_sel:[0,1,0] op_sel_hi:[1,1,1]
    v_pk_fma_f16 v135, v115, v102, v135 op_sel:[0,1,0] op_sel_hi:[1,1,1]
    v_pk_fma_f16 v183, v192, v105, v183 op_sel:[0,1,0] op_sel_hi:[1,1,1]
    v_pk_mul_f16 v120, v112, v103 op_sel_hi:[1,0]
    v_pk_fma_f16 v184, v225, v106, v184 op_sel:[0,1,0] op_sel_hi:[1,1,1]
    v_pk_mul_f16 v136, v128, v103 op_sel_hi:[1,0]
    v_pk_fma_f16 v191, v177, v98, v191 op_sel:[0,1,0] op_sel_hi:[1,1,1] neg_lo:[1,0,0] neg_hi:[1,0,0]
    v_pk_fma_f16 v120, v128, v103, v120 op_sel:[0,1,0] op_sel_hi:[1,1,1] neg_lo:[1,0,0] neg_hi:[1,0,0]
    v_pk_fma_f16 v193, v177, v104, v193 op_sel:[0,1,0] op_sel_hi:[1,1,1] neg_lo:[1,0,0] neg_hi:[1,0,0]
    v_pk_fma_f16 v136, v112, v103, v136 op_sel:[0,1,0] op_sel_hi:[1,1,1]
    v_pk_fma_f16 v195, v180, v105, v195 op_sel:[0,1,0] op_sel_hi:[1,1,1] neg_lo:[1,0,0] neg_hi:[1,0,0]
    v_pk_mul_f16 v121, v113, v103 op_sel_hi:[1,0]
    v_pk_fma_f16 v196, v224, v106, v196 op_sel:[0,1,0] op_sel_hi:[1,1,1] neg_lo:[1,0,0] neg_hi:[1,0,0]
    s_barrier
    v_pk_mul_f16 v137, v129, v103 op_sel_hi:[1,0]
    v_pk_mul_f16 v185, v184, v105 op_sel_hi:[1,0]
    v_pk_fma_f16 v121, v129, v103, v121 op_sel:[0,1,0] op_sel_hi:[1,1,1] neg_lo:[1,0,0] neg_hi:[1,0,0]
    v_pk_mul_f16 v186, v184, v106 op_sel_hi:[1,0]
    v_pk_fma_f16 v137, v113, v103, v137 op_sel:[0,1,0] op_sel_hi:[1,1,1]
    v_pk_mul_f16 v197, v196, v105 op_sel_hi:[1,0]
    v_pk_mul_f16 v122, v114, v103 op_sel_hi:[1,0]
    v_pk_mul_f16 v198, v196, v106 op_sel_hi:[1,0]
    v_pk_mul_f16 v138, v130, v103 op_sel_hi:[1,0]
    v_pk_fma_f16 v185, v196, v105, v185 op_sel:[0,1,0] op_sel_hi:[1,1,1]
    v_pk_fma_f16 v122, v130, v103, v122 op_sel:[0,1,0] op_sel_hi:[1,1,1] neg_lo:[1,0,0] neg_hi:[1,0,0]
    v_pk_fma_f16 v186, v196, v106, v186 op_sel:[0,1,0] op_sel_hi:[1,1,1]
    v_pk_fma_f16 v138, v114, v103, v138 op_sel:[0,1,0] op_sel_hi:[1,1,1]
    v_pk_fma_f16 v197, v184, v105, v197 op_sel:[0,1,0] op_sel_hi:[1,1,1] neg_lo:[1,0,0] neg_hi:[1,0,0]
    v_pk_mul_f16 v123, v115, v103 op_sel_hi:[1,0]
    v_pk_fma_f16 v198, v184, v106, v198 op_sel:[0,1,0] op_sel_hi:[1,1,1] neg_lo:[1,0,0] neg_hi:[1,0,0]
    v_pk_mul_f16 v139, v131, v103 op_sel_hi:[1,0]
    v_pk_fma_f16 v123, v131, v103, v123 op_sel:[0,1,0] op_sel_hi:[1,1,1] neg_lo:[1,0,0] neg_hi:[1,0,0]
    v_pk_fma_f16 v139, v115, v103, v139 op_sel:[0,1,0] op_sel_hi:[1,1,1]
    v_pk_mul_f16 v124, v116, v103 op_sel_hi:[1,0]
    v_pk_mul_f16 v140, v132, v103 op_sel_hi:[1,0]
    v_pk_fma_f16 v124, v132, v103, v124 op_sel:[0,1,0] op_sel_hi:[1,1,1] neg_lo:[1,0,0] neg_hi:[1,0,0]
    v_pk_fma_f16 v140, v116, v103, v140 op_sel:[0,1,0] op_sel_hi:[1,1,1]
    v_pk_mul_f16 v125, v117, v103 op_sel_hi:[1,0]
    v_pk_mul_f16 v141, v133, v103 op_sel_hi:[1,0]
    v_pk_fma_f16 v125, v133, v103, v125 op_sel:[0,1,0] op_sel_hi:[1,1,1] neg_lo:[1,0,0] neg_hi:[1,0,0]
    v_pk_fma_f16 v141, v117, v103, v141 op_sel:[0,1,0] op_sel_hi:[1,1,1]
    v_pk_mul_f16 v126, v118, v103 op_sel_hi:[1,0]
    v_pk_mul_f16 v142, v134, v103 op_sel_hi:[1,0]
    v_pk_fma_f16 v126, v134, v103, v126 op_sel:[0,1,0] op_sel_hi:[1,1,1] neg_lo:[1,0,0] neg_hi:[1,0,0]
    v_pk_fma_f16 v142, v118, v103, v142 op_sel:[0,1,0] op_sel_hi:[1,1,1]
    v_pk_mul_f16 v127, v119, v103 op_sel_hi:[1,0]
    v_pk_mul_f16 v143, v135, v103 op_sel_hi:[1,0]
    v_pk_fma_f16 v127, v135, v103, v127 op_sel:[0,1,0] op_sel_hi:[1,1,1] neg_lo:[1,0,0] neg_hi:[1,0,0]
    v_pk_fma_f16 v143, v119, v103, v143 op_sel:[0,1,0] op_sel_hi:[1,1,1]
    v_mov_b32 v211, 0
    v_mov_b32 v223, 0
    v_mul_f32 v2, 0x41000000, v29
    v_exp_f32 v4, v29
    v_mul_f32 v6, 0x43800000, v29
    v_mul_f32 v3, 0x41000000, v31
    v_fract_f32 v5, v31
    v_mul_f32 v7, 0x43800000, v31
    v_exp_f32 v2, v2
    v_cos_f32 v80, v5
    v_exp_f32 v6, v6
    v_fract_f32 v3, v3
    v_sin_f32 v81, v5
    v_fract_f32 v7, v7
    v_cos_f32 v92, v3
    v_mul_f32 v80, v80, v4
    v_cos_f32 v88, v7
    v_sin_f32 v93, v3
    v_mul_f32 v81, v81, v4
    v_sin_f32 v89, v7
    v_mul_f32 v92, v92, v2
    v_mul_f32 v88, v88, v6
    s_barrier
    s_mov_b32 s95, 0
L_zw:
    s_add_u32 s95, s95, 1
    s_waitcnt vmcnt(0)
    v_cmp_ne_u32 vcc, 1, v26
    s_cmp_gt_u32 s95, 0x20000
    s_cbranch_scc1 L_zok
    s_cbranch_vccz L_zok
    s_sleep 1
    buffer_load_dword v26, v36, s[52:55], 0 offen sc1
    s_branch L_zw
L_zok:
    s_lshl_b32 s94, s36, 7
    s_add_u32 s94, s94, 12881920
    v_mov_b32 v26, 1
    s_mov_b64 exec, 1
    buffer_atomic_add v26, v20, s[16:19], s94 offen
    s_mov_b64 exec, -1
    v_mul_f32 v93, v93, v2
    v_mul_f32 v89, v89, v6
    v_mul_f32 v94, s73, v33
    v_mul_f32 v95, -s73, v35
    v_mul_f32 v84, v92, v92
    v_cvt_pk_f16_f32 v98, v80, v81
    v_cvt_pk_f16_f32 v104, v88, v89
    v_mul_f32 v85, v92, v93
    v_mul_f32 v82, v80, v80
    v_mul_f32 v90, v88, v88
    v_fma_f32 v84, -v93, v93, v84
    v_mul_f32 v83, v80, v81
    v_mul_f32 v91, v88, v89
    v_add_f32 v85, v85, v85
    v_fma_f32 v82, -v81, v81, v82
    v_fma_f32 v90, -v89, v89, v90
    v_cvt_pk_f16_f32 v100, v84, v85
    v_add_f32 v83, v83, v83
    v_add_f32 v91, v91, v91
    v_mul_f32 v86, v84, v84
    v_cvt_pk_f16_f32 v99, v82, v83
    v_cvt_pk_f16_f32 v105, v90, v91
    v_mul_f32 v87, v84, v85
    v_mul_f32 v80, v82, v82
    v_mul_f32 v88, v90, v90
    v_fma_f32 v86, -v85, v85, v86
    v_mul_f32 v81, v82, v83
    v_mul_f32 v89, v90, v91
    v_add_f32 v87, v87, v87
    v_fma_f32 v80, -v83, v83, v80
    v_fma_f32 v88, -v91, v91, v88
    v_cvt_pk_f16_f32 v101, v86, v87
    v_add_f32 v81, v81, v81
    v_add_f32 v89, v89, v89
    v_mul_f32 v84, v86, v86
    v_mul_f32 v96, v94, v80
    v_cvt_pk_f16_f32 v106, v88, v89
    v_mul_f32 v85, v86, v87
    v_mul_f32 v97, v95, v80
    v_fma_f32 v84, -v87, v87, v84
    v_fma_f32 v96, v95, v81, v96
    v_add_f32 v85, v85, v85
    v_fma_f32 v97, -v94, v81, v97
    v_cvt_pk_f16_f32 v102, v84, v85
    v_mul_f32 v86, v84, v84
    v_mul_f32 v87, v84, v85
    v_fma_f32 v86, -v85, v85, v86
    v_add_f32 v87, v87, v87
    v_cvt_pk_f16_f32 v103, v86, v87
    v_cvt_pk_f16_f32 v200, v94, v96
    v_cvt_pk_f16_f32 v144, 1.0, v92
    v_cvt_pk_f16_f32 v212, v95, v97
    v_cvt_pk_f16_f32 v160, 0, v93
    v_pk_mul_f16 v201, v200, v99 op_sel_hi:[1,0]
    v_pk_mul_f16 v145, v144, v100 op_sel_hi:[1,0]
    v_pk_mul_f16 v204, v200, v104 op_sel_hi:[1,0]
    v_pk_mul_f16 v161, v160, v100 op_sel_hi:[1,0]
    v_pk_mul_f16 v202, v200, v98 op_sel_hi:[1,0]
    v_pk_fma_f16 v145, v160, v100, v145 op_sel:[0,1,0] op_sel_hi:[1,1,1] neg_lo:[1,0,0] neg_hi:[1,0,0]
    v_pk_mul_f16 v206, v200, v105 op_sel_hi:[1,0]
    v_pk_fma_f16 v161, v144, v100, v161 op_sel:[0,1,0] op_sel_hi:[1,1,1]
    v_pk_mul_f16 v213, v212, v99 op_sel_hi:[1,0]
    v_pk_mul_f16 v146, v144, v101 op_sel_hi:[1,0]
    v_pk_mul_f16 v216, v212, v104 op_sel_hi:[1,0]
    v_pk_mul_f16 v162, v160, v101 op_sel_hi:[1,0]
    v_pk_mul_f16 v214, v212, v98 op_sel_hi:[1,0]
    s_barrier
    v_pk_fma_f16 v146, v160, v101, v146 op_sel:[0,1,0] op_sel_hi:[1,1,1] neg_lo:[1,0,0] neg_hi:[1,0,0]
    v_pk_mul_f16 v218, v212, v105 op_sel_hi:[1,0]
    v_pk_fma_f16 v162, v144, v101, v162 op_sel:[0,1,0] op_sel_hi:[1,1,1]
    v_pk_fma_f16 v201, v212, v99, v201 op_sel:[0,1,0] op_sel_hi:[1,1,1]
    v_pk_mul_f16 v147, v145, v101 op_sel_hi:[1,0]
    v_pk_fma_f16 v204, v212, v104, v204 op_sel:[0,1,0] op_sel_hi:[1,1,1]
    v_pk_mul_f16 v163, v161, v101 op_sel_hi:[1,0]
    v_pk_fma_f16 v202, v212, v98, v202 op_sel:[0,1,0] op_sel_hi:[1,1,1]
    v_pk_fma_f16 v147, v161, v101, v147 op_sel:[0,1,0] op_sel_hi:[1,1,1] neg_lo:[1,0,0] neg_hi:[1,0,0]
    v_pk_fma_f16 v206, v212, v105, v206 op_sel:[0,1,0] op_sel_hi:[1,1,1]
    v_pk_fma_f16 v163, v145, v101, v163 op_sel:[0,1,0] op_sel_hi:[1,1,1]
    v_pk_fma_f16 v213, v200, v99, v213 op_sel:[0,1,0] op_sel_hi:[1,1,1] neg_lo:[1,0,0] neg_hi:[1,0,0]
    v_pk_mul_f16 v148, v144, v102 op_sel_hi:[1,0]
    v_pk_fma_f16 v216, v200, v104, v216 op_sel:[0,1,0] op_sel_hi:[1,1,1] neg_lo:[1,0,0] neg_hi:[1,0,0]
    v_pk_mul_f16 v164, v160, v102 op_sel_hi:[1,0]
    v_pk_fma_f16 v214, v200, v98, v214 op_sel:[0,1,0] op_sel_hi:[1,1,1] neg_lo:[1,0,0] neg_hi:[1,0,0]
    v_pk_fma_f16 v148, v160, v102, v148 op_sel:[0,1,0] op_sel_hi:[1,1,1] neg_lo:[1,0,0] neg_hi:[1,0,0]
    v_pk_fma_f16 v218, v200, v105, v218 op_sel:[0,1,0] op_sel_hi:[1,1,1] neg_lo:[1,0,0] neg_hi:[1,0,0]
    v_pk_fma_f16 v164, v144, v102, v164 op_sel:[0,1,0] op_sel_hi:[1,1,1]
    v_perm_b32 v224, v204, v200, s93
    v_pk_mul_f16 v149, v145, v102 op_sel_hi:[1,0]
    v_perm_b32 v225, v216, v212, s93
    v_pk_mul_f16 v165, v161, v102 op_sel_hi:[1,0]
    v_pk_mul_f16 v203, v201, v98 op_sel_hi:[1,0]
    v_pk_fma_f16 v149, v161, v102, v149 op_sel:[0,1,0] op_sel_hi:[1,1,1] neg_lo:[1,0,0] neg_hi:[1,0,0]
    v_pk_mul_f16 v205, v201, v104 op_sel_hi:[1,0]
    v_pk_fma_f16 v165, v145, v102, v165 op_sel:[0,1,0] op_sel_hi:[1,1,1]
    v_pk_mul_f16 v207, v204, v105 op_sel_hi:[1,0]
    v_pk_mul_f16 v150, v146, v102 op_sel_hi:[1,0]
    v_pk_mul_f16 v208, v224, v106 op_sel_hi:[1,0]
    v_pk_mul_f16 v166, v162, v102 op_sel_hi:[1,0]
    v_pk_mul_f16 v215, v213, v98 op_sel_hi:[1,0]
    v_pk_fma_f16 v150, v162, v102, v150 op_sel:[0,1,0] op_sel_hi:[1,1,1] neg_lo:[1,0,0] neg_hi:[1,0,0]
    v_pk_mul_f16 v217, v213, v104 op_sel_hi:[1,0]
    v_pk_fma_f16 v166, v146, v102, v166 op_sel:[0,1,0] op_sel_hi:[1,1,1]
    v_pk_mul_f16 v219, v216, v105 op_sel_hi:[1,0]
    v_pk_mul_f16 v151, v147, v102 op_sel_hi:[1,0]
    v_pk_mul_f16 v220, v225, v106 op_sel_hi:[1,0]
    v_pk_mul_f16 v167, v163, v102 op_sel_hi:[1,0]
    v_pk_fma_f16 v203, v213, v98, v203 op_sel:[0,1,0] op_sel_hi:[1,1,1]
    v_pk_fma_f16 v151, v163, v102, v151 op_sel:[0,1,0] op_sel_hi:[1,1,1] neg_lo:[1,0,0] neg_hi:[1,0,0]
    v_pk_fma_f16 v205, v213, v104, v205 op_sel:[0,1,0] op_sel_hi:[1,1,1]
    v_pk_fma_f16 v167, v147, v102, v167 op_sel:[0,1,0] op_sel_hi:[1,1,1]
    v_pk_fma_f16 v207, v216, v105, v207 op_sel:[0,1,0] op_sel_hi:[1,1,1]
    v_pk_mul_f16 v152, v144, v103 op_sel_hi:[1,0]
    v_pk_fma_f16 v208, v225, v106, v208 op_sel:[0,1,0] op_sel_hi:[1,1,1]
    v_pk_mul_f16 v168, v160, v103 op_sel_hi:[1,0]
    v_pk_fma_f16 v215, v201, v98, v215 op_sel:[0,1,0] op_sel_hi:[1,1,1] neg_lo:[1,0,0] neg_hi:[1,0,0]
    v_pk_fma_f16 v152, v160, v103, v152 op_sel:[0,1,0] op_sel_hi:[1,1,1] neg_lo:[1,0,0] neg_hi:[1,0,0]
    v_pk_fma_f16 v217, v201, v104, v217 op_sel:[0,1,0] op_sel_hi:[1,1,1] neg_lo:[1,0,0] neg_hi:[1,0,0]
    v_pk_fma_f16 v168, v144, v103, v168 op_sel:[0,1,0] op_sel_hi:[1,1,1]
    v_pk_fma_f16 v219, v204, v105, v219 op_sel:[0,1,0] op_sel_hi:[1,1,1] neg_lo:[1,0,0] neg_hi:[1,0,0]
    v_pk_mul_f16 v153, v145, v103 op_sel_hi:[1,0]
    v_pk_fma_f16 v220, v224, v106, v220 op_sel:[0,1,0] op_sel_hi:[1,1,1] neg_lo:[1,0,0] neg_hi:[1,0,0]
    v_pk_mul_f16 v169, v161, v103 op_sel_hi:[1,0]
    v_pk_mul_f16 v209, v208, v105 op_sel_hi:[1,0]
    v_pk_fma_f16 v153, v161, v103, v153 op_sel:[0,1,0] op_sel_hi:[1,1,1] neg_lo:[1,0,0] neg_hi:[1,0,0]
    v_pk_mul_f16 v210, v208, v106 op_sel_hi:[1,0]
    v_pk_fma_f16 v169, v145, v103, v169 op_sel:[0,1,0] op_sel_hi:[1,1,1]
    v_pk_mul_f16 v221, v220, v105 op_sel_hi:[1,0]
    v_pk_mul_f16 v154, v146, v103 op_sel_hi:[1,0]
    v_pk_mul_f16 v222, v220, v106 op_sel_hi:[1,0]
    v_pk_mul_f16 v170, v162, v103 op_sel_hi:[1,0]
    v_pk_fma_f16 v209, v220, v105, v209 op_sel:[0,1,0] op_sel_hi:[1,1,1]
    v_pk_fma_f16 v154, v162, v103, v154 op_sel:[0,1,0] op_sel_hi:[1,1,1] neg_lo:[1,0,0] neg_hi:[1,0,0]
    v_pk_fma_f16 v210, v220, v106, v210 op_sel:[0,1,0] op_sel_hi:[1,1,1]
    s_barrier
    v_pk_fma_f16 v170, v146, v103, v170 op_sel:[0,1,0] op_sel_hi:[1,1,1]
    v_pk_fma_f16 v221, v208, v105, v221 op_sel:[0,1,0] op_sel_hi:[1,1,1] neg_lo:[1,0,0] neg_hi:[1,0,0]
    v_pk_mul_f16 v155, v147, v103 op_sel_hi:[1,0]
    v_pk_fma_f16 v222, v208, v106, v222 op_sel:[0,1,0] op_sel_hi:[1,1,1] neg_lo:[1,0,0] neg_hi:[1,0,0]
    v_pk_mul_f16 v171, v163, v103 op_sel_hi:[1,0]
    v_pk_fma_f16 v155, v163, v103, v155 op_sel:[0,1,0] op_sel_hi:[1,1,1] neg_lo:[1,0,0] neg_hi:[1,0,0]
    v_pk_fma_f16 v171, v147, v103, v171 op_sel:[0,1,0] op_sel_hi:[1,1,1]
    v_pk_mul_f16 v156, v148, v103 op_sel_hi:[1,0]
    v_pk_mul_f16 v172, v164, v103 op_sel_hi:[1,0]
    v_pk_fma_f16 v156, v164, v103, v156 op_sel:[0,1,0] op_sel_hi:[1,1,1] neg_lo:[1,0,0] neg_hi:[1,0,0]
    v_pk_fma_f16 v172, v148, v103, v172 op_sel:[0,1,0] op_sel_hi:[1,1,1]
    v_pk_mul_f16 v157, v149, v103 op_sel_hi:[1,0]
    v_pk_mul_f16 v173, v165, v103 op_sel_hi:[1,0]
    v_pk_fma_f16 v157, v165, v103, v157 op_sel:[0,1,0] op_sel_hi:[1,1,1] neg_lo:[1,0,0] neg_hi:[1,0,0]
    v_pk_fma_f16 v173, v149, v103, v173 op_sel:[0,1,0] op_sel_hi:[1,1,1]
    v_pk_mul_f16 v158, v150, v103 op_sel_hi:[1,0]
    v_pk_mul_f16 v174, v166, v103 op_sel_hi:[1,0]
    v_pk_fma_f16 v158, v166, v103, v158 op_sel:[0,1,0] op_sel_hi:[1,1,1] neg_lo:[1,0,0] neg_hi:[1,0,0]
    v_pk_fma_f16 v174, v150, v103, v174 op_sel:[0,1,0] op_sel_hi:[1,1,1]
    v_pk_mul_f16 v159, v151, v103 op_sel_hi:[1,0]
    v_pk_mul_f16 v175, v167, v103 op_sel_hi:[1,0]
    v_pk_fma_f16 v159, v167, v103, v159 op_sel:[0,1,0] op_sel_hi:[1,1,1] neg_lo:[1,0,0] neg_hi:[1,0,0]
    v_pk_fma_f16 v175, v151, v103, v175 op_sel:[0,1,0] op_sel_hi:[1,1,1]
    v_mul_f32 v10, s72, v17
    v_and_b32 v12, 31, v0
    v_lshlrev_b32 v12, 2, v12
    v_add_u32 v12, s39, v12
    v_lshlrev_b32 v13, 7, v16
    v_mad_u32_u24 v2, v13, 1, v12
    v_mad_u32_u24 v3, v13, 15, v12
    v_mad_u32_u24 v4, v13, 10, v12
    v_mad_u32_u24 v5, v13, 4, v12
    v_mad_u32_u24 v6, v13, 6, v12
    v_lshl_add_u32 v9, v16, 2, v12
    v_mad_u32_u24 v226, v13, 17, v12
    v_mad_u32_u24 v227, v13, 16, v12
    v_mad_u32_u24 v228, v13, 7, v12
    v_mad_u32_u24 v229, v13, 7, v12
    v_mad_u32_u24 v230, v13, 6, v12
    v_mad_u32_u24 v231, v13, 5, v12
    v_mad_u32_u24 v232, v13, 5, v12
    v_mad_u32_u24 v233, v13, 10, v9
    v_lshlrev_b32 v8, 2, v0
    v_add_u32 v8, s39, v8
    v_add_u32 v234, 2304, v8
    v_lshlrev_b32 v235, 3, v0
    v_add_u32 v235, s39, v235
    v_add_u32 v235, 2560, v235
    v_cmp_eq_u32 s[74:75], 0, v0
    s_barrier
    s_lshr_b32 s98, s2, 4
    s_lshl_b32 s98, s98, 7
    s_add_u32 s98, s98, 12881920
    v_mov_b32 v26, 0
    s_mov_b64 exec, 1
    buffer_atomic_add v26, v20, s[16:19], s98 offen sc0
    s_mov_b64 exec, -1
    s_mov_b32 s56, s24
    s_mov_b32 s57, s25
    s_mov_b32 s58, 0x200000
    s_mov_b32 s59, 0x00020000
    v_lshrrev_b32 v38, 3, v0
    v_lshlrev_b32 v38, 11, v38
    v_and_b32 v37, 7, v0
    v_lshl_add_u32 v38, v37, 7, v38
    s_lshr_b32 s94, s2, 3
    s_lshl_b32 s94, s94, 16
    s_bfe_u32 s95, s2, 0x10002
    s_lshl_b32 s95, s95, 10
    s_add_u32 s94, s94, s95
    s_lshl_b32 s95, s37, 14
    s_add_u32 s94, s94, s95
    buffer_load_dword v18, v38, s[56:59], s94 offen
    ds_write_b128 v57, v[176:179]
    ds_write_b128 v57, v[188:191] offset:4096
    ds_write_b128 v58, v[180:183]
    ds_write_b128 v58, v[192:195] offset:4096
    ds_write_b128 v59, v[184:187]
    ds_write_b128 v59, v[196:199] offset:4096
    ds_read_b64_tr_b16 v[80:81], v61 offset:0
    ds_read_b64_tr_b16 v[82:83], v62 offset:256
    ds_read_b64_tr_b16 v[84:85], v61 offset:1024
    ds_read_b64_tr_b16 v[86:87], v62 offset:1280
    ds_read_b64_tr_b16 v[88:89], v61 offset:2048
    ds_read_b64_tr_b16 v[90:91], v62 offset:2304
    ds_read_b64_tr_b16 v[92:93], v61 offset:3072
    ds_read_b64_tr_b16 v[94:95], v62 offset:3328
    ds_read_b64_tr_b16 v[96:97], v61 offset:4096
    ds_read_b64_tr_b16 v[98:99], v62 offset:4352
    ds_read_b64_tr_b16 v[100:101], v61 offset:5120
    ds_read_b64_tr_b16 v[102:103], v62 offset:5376
    ds_read_b64_tr_b16 v[104:105], v61 offset:6144
    ds_read_b64_tr_b16 v[106:107], v62 offset:6400
    ds_read_b64_tr_b16 v[108:109], v61 offset:7168
    ds_read_b64_tr_b16 v[110:111], v62 offset:7424
    ds_write_b128 v57, v[112:115]
    ds_write_b128 v57, v[128:131] offset:4096
    s_barrier
    s_mov_b32 s95, 0
    s_branch L_apcx
L_apx:
    v_mov_b32 v26, 0
    s_mov_b64 exec, 1
    buffer_atomic_add v26, v20, s[16:19], s98 offen sc0
    s_mov_b64 exec, -1
L_apcx:
    s_add_u32 s95, s95, 1
    s_waitcnt vmcnt(0)
    v_readfirstlane_b32 s94, v26
    s_nop 0
    s_cmp_ge_u32 s94, 64
    s_cbranch_scc1 L_apdx
    s_cmp_gt_u32 s95, 0x20000
    s_cbranch_scc1 L_apdx
    s_sleep 2
    s_branch L_apx
L_apdx:
    s_mul_i32 s40, s37, 4608
    s_add_u32 s40, s40, 40960
    s_add_u32 m0, s40, 512
    s_lshl_b32 s94, s38, 12
    s_add_u32 s94, s94, 4194304
    buffer_load_dwordx4 v14, s[16:19], s94 offen offset:0 sc1 lds
    buffer_load_dwordx4 v14, s[16:19], s94 offen offset:1024 sc1 lds
    buffer_load_dwordx4 v14, s[16:19], s94 offen offset:2048 sc1 lds
    buffer_load_dwordx4 v14, s[16:19], s94 offen offset:3072 sc1 lds
    v_lshlrev_b32 v36, 3, v0
    v_add_u32 v36, s40, v36
    s_waitcnt lgkmcnt(0)
    ds_write_b64 v36, v[20:21]
    s_mul_i32 s44, s37, 10752
    s_add_u32 s44, s44, 79872
    v_mov_b32 v36, s44
    s_mov_b64 exec, 1
    ds_write_b128 v36, v[20:23] offset:0
    ds_write_b128 v36, v[20:23] offset:3200
    ds_write_b128 v36, v[20:23] offset:6400
    ds_write_b128 v36, v[20:23] offset:8496
    ds_write_b128 v36, v[20:23] offset:3088
    ds_write_b128 v36, v[20:23] offset:6288
    s_mov_b64 exec, -1
    s_waitcnt lgkmcnt(0)
    s_setprio 2
    ds_write_b128 v58, v[116:119]
    ds_write_b128 v58, v[132:135] offset:4096
    ds_write_b128 v59, v[120:123]
    ds_write_b128 v59, v[136:139] offset:4096
    ds_write_b128 v60, v[124:127]
    ds_write_b128 v60, v[140:143] offset:4096
    ds_read_b64_tr_b16 v[40:41], v61 offset:0
    ds_read_b64_tr_b16 v[42:43], v62 offset:256
    ds_read_b64_tr_b16 v[44:45], v61 offset:1024
    ds_read_b64_tr_b16 v[46:47], v62 offset:1280
    ds_read_b64_tr_b16 v[48:49], v61 offset:2048
    ds_read_b64_tr_b16 v[50:51], v62 offset:2304
    s_waitcnt lgkmcnt(4)
    v_mfma_f32_32x32x16_f16 v[64:79], v[80:83], v[40:43], 0
    ds_read_b64_tr_b16 v[52:53], v61 offset:3072
    ds_read_b64_tr_b16 v[54:55], v62 offset:3328
    s_waitcnt lgkmcnt(4)
    v_mfma_f32_32x32x16_f16 v[64:79], v[84:87], v[44:47], v[64:79]
    ds_read_b64_tr_b16 v[40:41], v61 offset:4096
    ds_read_b64_tr_b16 v[42:43], v62 offset:4352
    s_waitcnt lgkmcnt(4)
    v_mfma_f32_32x32x16_f16 v[64:79], v[88:91], v[48:51], v[64:79]
    ds_read_b64_tr_b16 v[44:45], v61 offset:5120
    ds_read_b64_tr_b16 v[46:47], v62 offset:5376
    s_waitcnt lgkmcnt(4)
    v_mfma_f32_32x32x16_f16 v[64:79], v[92:95], v[52:55], v[64:79]
    ds_read_b64_tr_b16 v[48:49], v61 offset:6144
    ds_read_b64_tr_b16 v[50:51], v62 offset:6400
    s_waitcnt lgkmcnt(4)
    v_mfma_f32_32x32x16_f16 v[64:79], v[96:99], v[40:43], v[64:79]
    ds_read_b64_tr_b16 v[52:53], v61 offset:7168
    ds_read_b64_tr_b16 v[54:55], v62 offset:7424
    s_waitcnt lgkmcnt(4)
    v_mfma_f32_32x32x16_f16 v[64:79], v[100:103], v[44:47], v[64:79]
    s_waitcnt lgkmcnt(2)
    v_mfma_f32_32x32x16_f16 v[64:79], v[104:107], v[48:51], v[64:79]
    s_waitcnt lgkmcnt(0)
    v_mfma_f32_32x32x16_f16 v[64:79], v[108:111], v[52:55], v[64:79]
    ds_write_b128 v57, v[200:203]
    ds_write_b128 v57, v[212:215] offset:4096
    ds_write_b128 v58, v[204:207]
    ds_write_b128 v58, v[216:219] offset:4096
    ds_write_b128 v59, v[208:211]
    ds_write_b128 v59, v[220:223] offset:4096
    ds_read_b64_tr_b16 v[80:81], v61 offset:0
    ds_read_b64_tr_b16 v[82:83], v62 offset:256
    ds_read_b64_tr_b16 v[84:85], v61 offset:1024
    ds_read_b64_tr_b16 v[86:87], v62 offset:1280
    ds_read_b64_tr_b16 v[88:89], v61 offset:2048
    ds_read_b64_tr_b16 v[90:91], v62 offset:2304
    ds_read_b64_tr_b16 v[92:93], v61 offset:3072
    ds_read_b64_tr_b16 v[94:95], v62 offset:3328
    ds_read_b64_tr_b16 v[96:97], v61 offset:4096
    ds_read_b64_tr_b16 v[98:99], v62 offset:4352
    ds_read_b64_tr_b16 v[100:101], v61 offset:5120
    ds_read_b64_tr_b16 v[102:103], v62 offset:5376
    ds_read_b64_tr_b16 v[104:105], v61 offset:6144
    ds_read_b64_tr_b16 v[106:107], v62 offset:6400
    ds_read_b64_tr_b16 v[108:109], v61 offset:7168
    ds_read_b64_tr_b16 v[110:111], v62 offset:7424
    ds_write_b128 v57, v[144:147]
    ds_write_b128 v57, v[160:163] offset:4096
    ds_write_b128 v58, v[148:151]
    ds_write_b128 v58, v[164:167] offset:4096
    ds_write_b128 v59, v[152:155]
    ds_write_b128 v59, v[168:171] offset:4096
    ds_write_b128 v60, v[156:159]
    ds_write_b128 v60, v[172:175] offset:4096
    ds_read_b64_tr_b16 v[40:41], v61 offset:0
    ds_read_b64_tr_b16 v[42:43], v62 offset:256
    ds_read_b64_tr_b16 v[44:45], v61 offset:1024
    ds_read_b64_tr_b16 v[46:47], v62 offset:1280
    ds_read_b64_tr_b16 v[48:49], v61 offset:2048
    ds_read_b64_tr_b16 v[50:51], v62 offset:2304
    s_waitcnt lgkmcnt(4)
    v_mfma_f32_32x32x16_f16 v[64:79], v[80:83], v[40:43], v[64:79]
    ds_read_b64_tr_b16 v[52:53], v61 offset:3072
    ds_read_b64_tr_b16 v[54:55], v62 offset:3328
    s_waitcnt lgkmcnt(4)
    v_mfma_f32_32x32x16_f16 v[64:79], v[84:87], v[44:47], v[64:79]
    ds_read_b64_tr_b16 v[40:41], v61 offset:4096
    ds_read_b64_tr_b16 v[42:43], v62 offset:4352
    s_waitcnt lgkmcnt(4)
    v_mfma_f32_32x32x16_f16 v[64:79], v[88:91], v[48:51], v[64:79]
    ds_read_b64_tr_b16 v[44:45], v61 offset:5120
    ds_read_b64_tr_b16 v[46:47], v62 offset:5376
    s_waitcnt lgkmcnt(4)
    v_mfma_f32_32x32x16_f16 v[64:79], v[92:95], v[52:55], v[64:79]
    ds_read_b64_tr_b16 v[48:49], v61 offset:6144
    ds_read_b64_tr_b16 v[50:51], v62 offset:6400
    s_waitcnt lgkmcnt(4)
    v_mfma_f32_32x32x16_f16 v[64:79], v[96:99], v[40:43], v[64:79]
    ds_read_b64_tr_b16 v[52:53], v61 offset:7168
    ds_read_b64_tr_b16 v[54:55], v62 offset:7424
    s_waitcnt lgkmcnt(4)
    v_mfma_f32_32x32x16_f16 v[64:79], v[100:103], v[44:47], v[64:79]
    s_waitcnt lgkmcnt(2)
    v_mfma_f32_32x32x16_f16 v[64:79], v[104:107], v[48:51], v[64:79]
    s_waitcnt lgkmcnt(0)
    v_mfma_f32_32x32x16_f16 v[64:79], v[108:111], v[52:55], v[64:79]
    s_nop 11
    v_mul_f32 v64, v64, v10
    ds_write_b32 v2, v64 offset:0
    v_mul_f32 v65, v65, v10
    ds_write_b32 v2, v65 offset:512
    v_mul_f32 v66, v66, v10
    ds_write_b32 v2, v66 offset:256
    v_mul_f32 v67, v67, v10
    ds_write_b32 v2, v67 offset:768
    v_mul_f32 v68, v68, v10
    ds_write_b32 v2, v68 offset:2176
    v_mul_f32 v69, v69, v10
    ds_write_b32 v3, v69 offset:1280
    v_mul_f32 v70, v70, v10
    ds_write_b32 v4, v70 offset:1152
    v_mul_f32 v71, v71, v10
    ds_write_b32 v3, v71 offset:1408
    v_mul_f32 v72, v72, v10
    ds_write_b32 v5, v72 offset:2560
    v_mul_f32 v73, v73, v10
    ds_write_b32 v6, v73 offset:2688
    v_mul_f32 v74, v74, v10
    ds_write_b32 v6, v74 offset:2816
    v_mul_f32 v75, v75, v10
    ds_write_b32 v6, v75 offset:2944
    ds_read_b32 v80, v226 offset:0
    ds_read_b32 v81, v227 offset:128
    ds_read_b32 v82, v228 offset:256
    ds_read_b32 v83, v229 offset:384
    ds_read_b32 v84, v230 offset:512
    ds_read_b32 v85, v231 offset:640
    ds_read_b32 v86, v232 offset:768
    ds_read_b32 v87, v233 offset:896
    ds_read2_b32 v[90:91], v234 offset0:0 offset1:1
    ds_read_b32 v92, v8 offset:3200
    ds_read2_b32 v[94:95], v235 offset0:1 offset1:2
    s_waitcnt lgkmcnt(0)
    s_mov_b32 s41, s39
    v_sub_u32 v5, 63, v0
    v_lshlrev_b32 v5, 4, v5
    v_add_u32 v5, s41, v5
    v_subrev_u32 v4, 960, v5
    v_lshrrev_b32 v6, 2, v0
    v_mul_u32_u24 v6, 1216, v6
    v_and_b32 v7, 3, v0
    v_lshl_add_u32 v6, v7, 3, v6
    v_add_u32 v6, s41, v6
    v_add_u32 v7, s41, v14
    v_lshlrev_b32 v8, 2, v0
    v_sub_u32 v8, 252, v8
    v_add_u32 v8, s41, v8
    v_cndmask_b32 v96, 0, v90, s[74:75]
    v_cndmask_b32 v97, 0, v92, s[74:75]
    v_cndmask_b32 v98, v92, 0, s[74:75]
    v_cvt_pk_bf16_f32 v99, v91, v98
    v_cvt_pk_bf16_f32 v100, v95, v94
    v_cvt_pk_bf16_f32 v101, v91, v91
    s_mov_b32 s46, 0
    s_mov_b32 s47, 0
    v_readlane_b32 s48, v101, 63
    ds_write_b128 v7, v[20:23] offset:4864
    s_mov_b64 exec, 0xffff
    ds_write_b128 v7, v[20:23] offset:5888
    ds_write_b64 v6, v[20:21] offset:1088
    s_mov_b64 exec, -1
    ds_write_b32 v8, v99 offset:5000
    ds_write_b32 v8, v100 offset:5380
    ds_write_b32 v8, v100 offset:5768
    v_cvt_pk_bf16_f32 v112, v87, v86
    v_cvt_pk_bf16_f32 v113, v85, v84
    v_cvt_pk_bf16_f32 v114, v83, v82
    v_cvt_pk_bf16_f32 v115, v81, v80
    v_mov_b32 v123, s46
    v_mov_b32 v224, s47
    v_cvt_pk_bf16_f32 v120, v85, v84
    v_cvt_pk_bf16_f32 v121, v83, v82
    v_cvt_pk_bf16_f32 v122, v81, v80
    v_mov_b32_dpp v123, v112 wave_shr:1 row_mask:0xf bank_mask:0xf
    v_mov_b32_dpp v224, v113 wave_shr:1 row_mask:0xf bank_mask:0xf
    v_readlane_b32 s46, v112, 63
    v_readlane_b32 s47, v113, 63
    v_cvt_pk_bf16_f32 v116, v86, v85
    v_cvt_pk_bf16_f32 v117, v84, v83
    v_cvt_pk_bf16_f32 v118, v82, v81
    v_alignbit_b32 v119, v123, v115, 16
    v_cvt_pk_bf16_f32 v124, v84, v83
    v_cvt_pk_bf16_f32 v125, v82, v81
    v_alignbit_b32 v126, v123, v115, 16
    v_alignbit_b32 v127, v224, v123, 16
    ds_write_b128 v5, v[112:115] offset:64
    ds_write_b128 v5, v[116:119] offset:1280
    ds_write_b128 v5, v[120:123] offset:2496
    ds_write_b128 v5, v[124:127] offset:3712
    v_cvt_pk_bf16_f32 v128, v20, v20
    v_cvt_pk_bf16_f32 v129, v97, v97
    v_cvt_pk_bf16_f32 v130, v97, v96
    v_cvt_pk_bf16_f32 v131, v96, v96
    v_mov_b32 v139, s46
    v_mov_b32 v225, s47
    v_cvt_pk_bf16_f32 v136, v97, v97
    v_cvt_pk_bf16_f32 v137, v97, v96
    v_cvt_pk_bf16_f32 v138, v96, v96
    v_mov_b32_dpp v139, v128 wave_shr:1 row_mask:0xf bank_mask:0xf
    v_mov_b32_dpp v225, v129 wave_shr:1 row_mask:0xf bank_mask:0xf
    v_readlane_b32 s46, v128, 63
    v_readlane_b32 s47, v129, 63
    v_cvt_pk_bf16_f32 v132, v20, v97
    v_cvt_pk_bf16_f32 v133, v97, v97
    v_cvt_pk_bf16_f32 v134, v96, v96
    v_alignbit_b32 v135, v139, v131, 16
    v_cvt_pk_bf16_f32 v140, v97, v97
    v_cvt_pk_bf16_f32 v141, v96, v96
    v_alignbit_b32 v142, v139, v131, 16
    v_alignbit_b32 v143, v225, v139, 16
    s_mov_b64 exec, 15
    ds_write_b128 v4, v[128:131] offset:0
    ds_write_b128 v4, v[132:135] offset:1216
    ds_write_b128 v4, v[136:139] offset:2432
    ds_write_b128 v4, v[140:143] offset:3648
    s_mov_b64 exec, -1
    v_and_b32 v4, 3, v0
    v_xor_b32 v4, 3, v4
    v_mul_u32_u24 v4, 1216, v4
    v_and_b32 v3, 12, v0
    v_lshlrev_b32 v3, 1, v3
    v_sub_u32 v4, v4, v3
    v_lshrrev_b32 v2, 4, v0
    v_lshl_add_u32 v4, v2, 4, v4
    s_add_u32 s42, s41, 536
    v_add_u32 v24, s42, v4
    v_subrev_u32 v25, 512, v24
    v_and_b32 v9, 15, v0
    v_lshlrev_b32 v3, 5, v9
    v_lshl_add_u32 v7, v2, 4, v3
    s_add_u32 s42, s40, 480
    v_add_u32 v26, s42, v7
    v_lshl_add_u32 v27, v2, 3, v3
    v_bfe_u32 v28, v0, 4, 1
    v_lshl_add_u32 v28, v28, 9, v3
    v_lshrrev_b32 v12, 5, v0
    v_lshl_add_u32 v28, v12, 4, v28
    v_lshlrev_b32 v10, 4, v2
    v_lshlrev_b32 v11, 3, v9
    v_sub_u32 v11, v10, v11
    s_add_u32 s42, s41, 4992
    v_add_u32 v29, s42, v11
    v_lshlrev_b32 v11, 2, v9
    v_sub_u32 v11, v10, v11
    v_and_b32 v12, 1, v0
    v_mul_u32_u24 v12, 388, v12
    s_add_u32 s42, s41, 5440
    v_add3_u32 v30, s42, v11, v12
    v_bfe_u32 v11, v0, 2, 2
    v_lshl_add_u32 v11, v2, 3, v11
    v_and_b32 v12, 3, v0
    v_lshlrev_b32 v12, 3, v12
    v_bfe_u32 v13, v0, 2, 1
    v_mul_u32_u24 v31, 3200, v13
    v_mul_u32_u24 v32, 2096, v13
    v_lshl_add_u32 v31, v11, 3, v31
    v_lshl_add_u32 v32, v11, 4, v32
    v_add3_u32 v31, v31, v12, s44
    v_add3_u32 v32, v32, v12, s44
    v_lshlrev_b32 v11, 5, v0
    v_add_u32 v33, s40, v11
    v_add_u32 v35, s44, v11
    v_add_u32 v34, s40, v14
    v_add_u32 v36, s44, v14
    v_lshlrev_b32 v10, 3, v2
    v_sub_u32 v10, v10, v9
    s_lshl_b32 s49, s48, 16
    s_lshr_b32 s45, s48, 16
    s_waitcnt vmcnt(0) lgkmcnt(0)
    s_setprio 2
    ds_read_b64 v[72:73], v24 offset:512
    ds_read_b64 v[74:75], v24 offset:520
    ds_read_b64 v[76:77], v24 offset:0
    ds_read_b64 v[78:79], v24 offset:8
    ds_read_b128 v[96:99], v26 offset:0
    ds_read_b128 v[100:103], v26 offset:512
    ds_read_b128 v[104:107], v26 offset:1024
    ds_read_b128 v[108:111], v26 offset:1536
    ds_read_b128 v[112:115], v26 offset:2048
    ds_read_b128 v[116:119], v26 offset:2560
    ds_read_b128 v[120:123], v26 offset:3072
    ds_read_b128 v[124:127], v26 offset:3584
    ds_read_b64 v[88:89], v25
    ds_read_b64 v[90:91], v25 offset:8
    ds_read_b64 v[160:161], v33 offset:488
    ds_read_b128 v[164:167], v33 offset:496
    ds_read_b128 v[168:171], v33 offset:512
    ds_read_b64 v[162:163], v33 offset:528
    ds_read_b64 v[236:237], v34 offset:2536
    ds_read_b128 v[240:243], v34 offset:2544
    ds_read_b64 v[238:239], v34 offset:2560
    v_mov_b32 v92, 0
    v_mov_b32 v11, s49
    v_cmp_eq_u32 vcc, 11, v10
    s_nop 1
    v_cndmask_b32 v92, v92, v11, vcc
    v_mov_b32 v11, s48
    v_cmp_eq_u32 vcc, 12, v10
    s_nop 1
    v_cndmask_b32 v92, v92, v11, vcc
    v_mov_b32 v11, s45
    v_cmp_eq_u32 vcc, 13, v10
    s_nop 1
    v_cndmask_b32 v92, v92, v11, vcc
    v_mov_b32 v93, 0
    v_mov_b32 v11, s49
    v_cmp_eq_u32 vcc, 9, v10
    s_nop 1
    v_cndmask_b32 v93, v93, v11, vcc
    v_mov_b32 v11, s48
    v_cmp_eq_u32 vcc, 10, v10
    s_nop 1
    v_cndmask_b32 v93, v93, v11, vcc
    v_mov_b32 v11, s45
    v_cmp_eq_u32 vcc, 11, v10
    s_nop 1
    v_cndmask_b32 v93, v93, v11, vcc
    v_mov_b32 v94, 0
    v_mov_b32 v11, s49
    v_cmp_eq_u32 vcc, 7, v10
    s_nop 1
    v_cndmask_b32 v94, v94, v11, vcc
    v_mov_b32 v11, s48
    v_cmp_eq_u32 vcc, 8, v10
    s_nop 1
    v_cndmask_b32 v94, v94, v11, vcc
    v_mov_b32 v11, s45
    v_cmp_eq_u32 vcc, 9, v10
    s_nop 1
    v_cndmask_b32 v94, v94, v11, vcc
    v_mov_b32 v95, 0
    v_mov_b32 v11, s49
    v_cmp_eq_u32 vcc, 5, v10
    s_nop 1
    v_cndmask_b32 v95, v95, v11, vcc
    v_mov_b32 v11, s48
    v_cmp_eq_u32 vcc, 6, v10
    s_nop 1
    v_cndmask_b32 v95, v95, v11, vcc
    v_mov_b32 v11, s45
    v_cmp_eq_u32 vcc, 7, v10
    s_nop 1
    v_cndmask_b32 v95, v95, v11, vcc
    v_subrev_u32 v24, 64, v24
    v_subrev_u32 v26, 64, v26
    s_waitcnt lgkmcnt(0)
    v_mfma_f32_16x16x32_bf16 v[40:43], v[72:75], v[96:99], 0
    ds_read_b64 v[80:81], v24 offset:512
    v_lshlrev_b32 v172, 16, v160
    v_and_b32 v173, 0xffff0000, v160
    v_mfma_f32_16x16x32_bf16 v[44:47], v[76:79], v[96:99], 0
    ds_read_b64 v[82:83], v24 offset:520
    v_lshlrev_b32 v174, 16, v161
    v_and_b32 v175, 0xffff0000, v161
    v_mfma_f32_16x16x32_bf16 v[48:51], v[88:91], v[96:99], 0
    ds_read_b64 v[84:85], v24 offset:0
    v_lshlrev_b32 v176, 16, v164
    v_and_b32 v177, 0xffff0000, v164
    v_mfma_f32_16x16x32_bf16 v[56:59], v[92:95], v[96:99], 0
    ds_read_b64 v[86:87], v24 offset:8
    v_lshlrev_b32 v178, 16, v165
    v_and_b32 v179, 0xffff0000, v165
    v_mfma_f32_16x16x32_bf16 v[44:47], v[72:75], v[100:103], v[44:47]
    ds_read_b128 v[128:131], v26 offset:0
    v_lshlrev_b32 v180, 16, v166
    v_mfma_f32_16x16x32_bf16 v[48:51], v[76:79], v[100:103], v[48:51]
    ds_read_b128 v[132:135], v26 offset:512
    v_and_b32 v181, 0xffff0000, v166
    v_lshlrev_b32 v182, 16, v167
    v_mfma_f32_16x16x32_bf16 v[52:55], v[88:91], v[100:103], 0
    ds_read_b128 v[136:139], v26 offset:1024
    v_and_b32 v183, 0xffff0000, v167
    v_lshlrev_b32 v184, 16, v168
    v_mfma_f32_16x16x32_bf16 v[60:63], v[92:95], v[100:103], 0
    ds_read_b128 v[140:143], v26 offset:1536
    v_and_b32 v185, 0xffff0000, v168
    v_lshlrev_b32 v186, 16, v169
    v_mfma_f32_16x16x32_bf16 v[48:51], v[72:75], v[104:107], v[48:51]
    ds_read_b128 v[144:147], v26 offset:2048
    v_and_b32 v187, 0xffff0000, v169
    v_lshlrev_b32 v188, 16, v170
    v_mfma_f32_16x16x32_bf16 v[52:55], v[76:79], v[104:107], v[52:55]
    ds_read_b128 v[148:151], v26 offset:2560
    v_and_b32 v189, 0xffff0000, v170
    v_mfma_f32_16x16x32_bf16 v[56:59], v[88:91], v[104:107], v[56:59]
    ds_read_b128 v[152:155], v26 offset:3072
    v_lshlrev_b32 v190, 16, v171
    v_and_b32 v191, 0xffff0000, v171
    v_mfma_f32_16x16x32_bf16 v[64:67], v[92:95], v[104:107], 0
    ds_read_b128 v[156:159], v26 offset:3584
    v_lshlrev_b32 v192, 16, v162
    v_and_b32 v193, 0xffff0000, v162
    v_mfma_f32_16x16x32_bf16 v[52:55], v[72:75], v[108:111], v[52:55]
    v_lshlrev_b32 v194, 16, v163
    v_and_b32 v195, 0xffff0000, v163
    v_mfma_f32_16x16x32_bf16 v[56:59], v[76:79], v[108:111], v[56:59]
    v_add_f32 v196, v172, v173
    v_mfma_f32_16x16x32_bf16 v[60:63], v[88:91], v[108:111], v[60:63]
    v_add_f32 v197, v173, v174
    v_add_f32 v198, v174, v175
    v_mfma_f32_16x16x32_bf16 v[68:71], v[92:95], v[108:111], 0
    v_add_f32 v199, v175, v176
    v_add_f32 v200, v176, v177
    v_mfma_f32_16x16x32_bf16 v[56:59], v[72:75], v[112:115], v[56:59]
    v_add_f32 v201, v177, v178
    v_add_f32 v202, v178, v179
    v_mfma_f32_16x16x32_bf16 v[60:63], v[76:79], v[112:115], v[60:63]
    v_add_f32 v203, v179, v180
    v_add_f32 v204, v180, v181
    v_mfma_f32_16x16x32_bf16 v[64:67], v[88:91], v[112:115], v[64:67]
    v_add_f32 v205, v181, v182
    v_mfma_f32_16x16x32_bf16 v[60:63], v[72:75], v[116:119], v[60:63]
    v_add_f32 v206, v182, v183
    v_add_f32 v207, v183, v184
    v_mfma_f32_16x16x32_bf16 v[64:67], v[76:79], v[116:119], v[64:67]
    v_add_f32 v208, v184, v185
    v_add_f32 v209, v185, v186
    v_mfma_f32_16x16x32_bf16 v[68:71], v[88:91], v[116:119], v[68:71]
    v_add_f32 v210, v186, v187
    v_add_f32 v211, v187, v188
    v_mfma_f32_16x16x32_bf16 v[64:67], v[72:75], v[120:123], v[64:67]
    v_add_f32 v212, v188, v189
    v_mfma_f32_16x16x32_bf16 v[68:71], v[76:79], v[120:123], v[68:71]
    v_add_f32 v213, v189, v190
    v_add_f32 v214, v190, v191
    v_mfma_f32_16x16x32_bf16 v[68:71], v[72:75], v[124:127], v[68:71]
    v_add_f32 v215, v191, v192
    v_add_f32 v216, v192, v193
    v_subrev_u32 v24, 64, v24
    v_subrev_u32 v26, 64, v26
    s_waitcnt lgkmcnt(0)
    v_mfma_f32_16x16x32_bf16 v[40:43], v[80:83], v[128:131], v[40:43]
    ds_read_b64 v[72:73], v24 offset:512
    v_add_f32 v217, v193, v194
    v_add_f32 v177, v199, v177
    v_mfma_f32_16x16x32_bf16 v[44:47], v[84:87], v[128:131], v[44:47]
    ds_read_b64 v[74:75], v24 offset:520
    v_add_f32 v178, v200, v178
    v_add_f32 v179, v201, v179
    v_mfma_f32_16x16x32_bf16 v[44:47], v[80:83], v[132:135], v[44:47]
    ds_read_b64 v[76:77], v24 offset:0
    v_add_f32 v180, v202, v180
    v_mfma_f32_16x16x32_bf16 v[48:51], v[84:87], v[132:135], v[48:51]
    ds_read_b64 v[78:79], v24 offset:8
    v_add_f32 v181, v203, v181
    v_add_f32 v182, v204, v182
    v_mfma_f32_16x16x32_bf16 v[48:51], v[80:83], v[136:139], v[48:51]
    ds_read_b128 v[96:99], v26 offset:0
    v_add_f32 v183, v205, v183
    v_add_f32 v184, v206, v184
    v_mfma_f32_16x16x32_bf16 v[52:55], v[84:87], v[136:139], v[52:55]
    ds_read_b128 v[100:103], v26 offset:512
    v_add_f32 v185, v207, v185
    v_add_f32 v186, v208, v186
    v_mfma_f32_16x16x32_bf16 v[52:55], v[80:83], v[140:143], v[52:55]
    ds_read_b128 v[104:107], v26 offset:1024
    v_add_f32 v187, v209, v187
    v_add_f32 v188, v210, v188
    v_mfma_f32_16x16x32_bf16 v[56:59], v[84:87], v[140:143], v[56:59]
    ds_read_b128 v[108:111], v26 offset:1536
    v_add_f32 v189, v211, v189
    v_mfma_f32_16x16x32_bf16 v[56:59], v[80:83], v[144:147], v[56:59]
    ds_read_b128 v[112:115], v26 offset:2048
    v_add_f32 v190, v212, v190
    v_add_f32 v191, v213, v191
    v_mfma_f32_16x16x32_bf16 v[60:63], v[84:87], v[144:147], v[60:63]
    ds_read_b128 v[116:119], v26 offset:2560
    v_add_f32 v192, v214, v192
    v_add_f32 v193, v215, v193
    v_mfma_f32_16x16x32_bf16 v[60:63], v[80:83], v[148:151], v[60:63]
    ds_read_b128 v[120:123], v26 offset:3072
    v_add_f32 v194, v216, v194
    v_add_f32 v195, v217, v195
    v_mfma_f32_16x16x32_bf16 v[64:67], v[84:87], v[148:151], v[64:67]
    ds_read_b128 v[124:127], v26 offset:3584
    v_cvt_pk_bf16_f32 v220, v177, v178
    v_mfma_f32_16x16x32_bf16 v[64:67], v[80:83], v[152:155], v[64:67]
    v_cvt_pk_bf16_f32 v221, v179, v180
    v_cvt_pk_bf16_f32 v222, v181, v182
    v_mfma_f32_16x16x32_bf16 v[68:71], v[84:87], v[152:155], v[68:71]
    v_cvt_pk_bf16_f32 v223, v183, v184
    v_cvt_pk_bf16_f32 v224, v185, v186
    v_mfma_f32_16x16x32_bf16 v[68:71], v[80:83], v[156:159], v[68:71]
    v_cvt_pk_bf16_f32 v225, v187, v188
    v_cvt_pk_bf16_f32 v226, v189, v190
    v_subrev_u32 v24, 64, v24
    v_subrev_u32 v26, 64, v26
    s_waitcnt lgkmcnt(0)
    v_mfma_f32_16x16x32_bf16 v[40:43], v[72:75], v[96:99], v[40:43]
    ds_read_b64 v[80:81], v24 offset:512
    v_cvt_pk_bf16_f32 v227, v191, v192
    ds_write_b128 v35, v[220:223] offset:3216
    v_mfma_f32_16x16x32_bf16 v[44:47], v[76:79], v[96:99], v[44:47]
    ds_read_b64 v[82:83], v24 offset:520
    ds_write_b128 v35, v[224:227] offset:3232
    v_mfma_f32_16x16x32_bf16 v[44:47], v[72:75], v[100:103], v[44:47]
    ds_read_b64 v[84:85], v24 offset:0
    v_add_f32 v178, v198, v178
    v_add_f32 v179, v199, v179
    v_mfma_f32_16x16x32_bf16 v[48:51], v[76:79], v[100:103], v[48:51]
    ds_read_b64 v[86:87], v24 offset:8
    v_add_f32 v180, v200, v180
    v_add_f32 v181, v201, v181
    v_mfma_f32_16x16x32_bf16 v[48:51], v[72:75], v[104:107], v[48:51]
    ds_read_b128 v[128:131], v26 offset:0
    v_add_f32 v182, v202, v182
    v_add_f32 v183, v203, v183
    v_mfma_f32_16x16x32_bf16 v[52:55], v[76:79], v[104:107], v[52:55]
    ds_read_b128 v[132:135], v26 offset:512
    v_add_f32 v184, v204, v184
    v_mfma_f32_16x16x32_bf16 v[52:55], v[72:75], v[108:111], v[52:55]
    ds_read_b128 v[136:139], v26 offset:1024
    v_add_f32 v185, v205, v185
    v_add_f32 v186, v206, v186
    v_mfma_f32_16x16x32_bf16 v[56:59], v[76:79], v[108:111], v[56:59]
    ds_read_b128 v[140:143], v26 offset:1536
    v_add_f32 v187, v207, v187
    v_add_f32 v188, v208, v188
    v_mfma_f32_16x16x32_bf16 v[56:59], v[72:75], v[112:115], v[56:59]
    ds_read_b128 v[144:147], v26 offset:2048
    v_add_f32 v189, v209, v189
    v_add_f32 v190, v210, v190
    v_mfma_f32_16x16x32_bf16 v[60:63], v[76:79], v[112:115], v[60:63]
    ds_read_b128 v[148:151], v26 offset:2560
    v_add_f32 v191, v211, v191
    v_add_f32 v192, v212, v192
    v_mfma_f32_16x16x32_bf16 v[60:63], v[72:75], v[116:119], v[60:63]
    ds_read_b128 v[152:155], v26 offset:3072
    v_add_f32 v193, v213, v193
    v_mfma_f32_16x16x32_bf16 v[64:67], v[76:79], v[116:119], v[64:67]
    ds_read_b128 v[156:159], v26 offset:3584
    v_add_f32 v194, v214, v194
    v_add_f32 v195, v215, v195
    v_mfma_f32_16x16x32_bf16 v[64:67], v[72:75], v[120:123], v[64:67]
    v_cvt_pk_bf16_f32 v228, v178, v179
    v_cvt_pk_bf16_f32 v229, v180, v181
    v_mfma_f32_16x16x32_bf16 v[68:71], v[76:79], v[120:123], v[68:71]
    v_cvt_pk_bf16_f32 v230, v182, v183
    v_cvt_pk_bf16_f32 v231, v184, v185
    v_mfma_f32_16x16x32_bf16 v[68:71], v[72:75], v[124:127], v[68:71]
    v_cvt_pk_bf16_f32 v232, v186, v187
    v_cvt_pk_bf16_f32 v233, v188, v189
    v_subrev_u32 v24, 64, v24
    v_subrev_u32 v26, 64, v26
    s_waitcnt lgkmcnt(0)
    v_mfma_f32_16x16x32_bf16 v[40:43], v[80:83], v[128:131], v[40:43]
    ds_read_b64 v[72:73], v24 offset:512
    v_cvt_pk_bf16_f32 v234, v190, v191
    v_mfma_f32_16x16x32_bf16 v[44:47], v[84:87], v[128:131], v[44:47]
    ds_read_b64 v[74:75], v24 offset:520
    v_cvt_pk_bf16_f32 v235, v192, v193
    ds_write_b128 v35, v[228:231] offset:16
    v_mfma_f32_16x16x32_bf16 v[44:47], v[80:83], v[132:135], v[44:47]
    ds_read_b64 v[76:77], v24 offset:0
    ds_write_b128 v35, v[232:235] offset:32
    v_add_f32 v179, v197, v179
    v_mfma_f32_16x16x32_bf16 v[48:51], v[84:87], v[132:135], v[48:51]
    ds_read_b64 v[78:79], v24 offset:8
    v_add_f32 v180, v198, v180
    v_add_f32 v181, v199, v181
    v_mfma_f32_16x16x32_bf16 v[48:51], v[80:83], v[136:139], v[48:51]
    ds_read_b128 v[96:99], v26 offset:0
    v_add_f32 v182, v200, v182
    v_mfma_f32_16x16x32_bf16 v[52:55], v[84:87], v[136:139], v[52:55]
    ds_read_b128 v[100:103], v26 offset:512
    v_add_f32 v183, v201, v183
    v_add_f32 v184, v202, v184
    v_mfma_f32_16x16x32_bf16 v[52:55], v[80:83], v[140:143], v[52:55]
    ds_read_b128 v[104:107], v26 offset:1024
    v_add_f32 v185, v203, v185
    v_add_f32 v186, v204, v186
    v_mfma_f32_16x16x32_bf16 v[56:59], v[84:87], v[140:143], v[56:59]
    ds_read_b128 v[108:111], v26 offset:1536
    v_add_f32 v187, v205, v187
    v_add_f32 v188, v206, v188
    v_mfma_f32_16x16x32_bf16 v[56:59], v[80:83], v[144:147], v[56:59]
    ds_read_b128 v[112:115], v26 offset:2048
    v_add_f32 v189, v207, v189
    v_add_f32 v190, v208, v190
    v_mfma_f32_16x16x32_bf16 v[60:63], v[84:87], v[144:147], v[60:63]
    ds_read_b128 v[116:119], v26 offset:2560
    v_add_f32 v191, v209, v191
    v_mfma_f32_16x16x32_bf16 v[60:63], v[80:83], v[148:151], v[60:63]
    ds_read_b128 v[120:123], v26 offset:3072
    v_add_f32 v192, v210, v192
    v_add_f32 v193, v211, v193
    v_mfma_f32_16x16x32_bf16 v[64:67], v[84:87], v[148:151], v[64:67]
    ds_read_b128 v[124:127], v26 offset:3584
    v_add_f32 v194, v212, v194
    v_add_f32 v195, v213, v195
    v_mfma_f32_16x16x32_bf16 v[64:67], v[80:83], v[152:155], v[64:67]
    v_cvt_pk_bf16_f32 v220, v179, v180
    v_cvt_pk_bf16_f32 v221, v181, v182
    v_mfma_f32_16x16x32_bf16 v[68:71], v[84:87], v[152:155], v[68:71]
    v_cvt_pk_bf16_f32 v222, v183, v184
    v_mfma_f32_16x16x32_bf16 v[68:71], v[80:83], v[156:159], v[68:71]
    v_cvt_pk_bf16_f32 v223, v185, v186
    v_cvt_pk_bf16_f32 v224, v187, v188
    v_subrev_u32 v24, 64, v24
    v_subrev_u32 v26, 64, v26
    s_waitcnt lgkmcnt(0)
    v_mfma_f32_16x16x32_bf16 v[40:43], v[72:75], v[96:99], v[40:43]
    ds_read_b64 v[80:81], v24 offset:512
    v_cvt_pk_bf16_f32 v225, v189, v190
    v_cvt_pk_bf16_f32 v226, v191, v192
    v_mfma_f32_16x16x32_bf16 v[44:47], v[76:79], v[96:99], v[44:47]
    ds_read_b64 v[82:83], v24 offset:520
    v_cvt_pk_bf16_f32 v227, v193, v194
    ds_write_b128 v35, v[220:223] offset:8512
    v_mfma_f32_16x16x32_bf16 v[44:47], v[72:75], v[100:103], v[44:47]
    ds_read_b64 v[84:85], v24 offset:0
    ds_write_b128 v35, v[224:227] offset:8528
    v_add_f32 v180, v196, v180
    v_mfma_f32_16x16x32_bf16 v[48:51], v[76:79], v[100:103], v[48:51]
    ds_read_b64 v[86:87], v24 offset:8
    v_add_f32 v181, v197, v181
    v_mfma_f32_16x16x32_bf16 v[48:51], v[72:75], v[104:107], v[48:51]
    ds_read_b128 v[128:131], v26 offset:0
    v_add_f32 v182, v198, v182
    v_add_f32 v183, v199, v183
    v_mfma_f32_16x16x32_bf16 v[52:55], v[76:79], v[104:107], v[52:55]
    ds_read_b128 v[132:135], v26 offset:512
    v_add_f32 v184, v200, v184
    v_add_f32 v185, v201, v185
    v_mfma_f32_16x16x32_bf16 v[52:55], v[72:75], v[108:111], v[52:55]
    ds_read_b128 v[136:139], v26 offset:1024
    v_add_f32 v186, v202, v186
    v_add_f32 v187, v203, v187
    v_mfma_f32_16x16x32_bf16 v[56:59], v[76:79], v[108:111], v[56:59]
    ds_read_b128 v[140:143], v26 offset:1536
    v_add_f32 v188, v204, v188
    v_add_f32 v189, v205, v189
    v_mfma_f32_16x16x32_bf16 v[56:59], v[72:75], v[112:115], v[56:59]
    ds_read_b128 v[144:147], v26 offset:2048
    v_add_f32 v190, v206, v190
    v_mfma_f32_16x16x32_bf16 v[60:63], v[76:79], v[112:115], v[60:63]
    ds_read_b128 v[148:151], v26 offset:2560
    v_add_f32 v191, v207, v191
    v_add_f32 v192, v208, v192
    v_mfma_f32_16x16x32_bf16 v[60:63], v[72:75], v[116:119], v[60:63]
    ds_read_b128 v[152:155], v26 offset:3072
    v_add_f32 v193, v209, v193
    v_add_f32 v194, v210, v194
    v_mfma_f32_16x16x32_bf16 v[64:67], v[76:79], v[116:119], v[64:67]
    ds_read_b128 v[156:159], v26 offset:3584
    v_add_f32 v195, v211, v195
    v_cvt_pk_bf16_f32 v228, v180, v181
    v_mfma_f32_16x16x32_bf16 v[64:67], v[72:75], v[120:123], v[64:67]
    v_cvt_pk_bf16_f32 v229, v182, v183
    v_mfma_f32_16x16x32_bf16 v[68:71], v[76:79], v[120:123], v[68:71]
    v_cvt_pk_bf16_f32 v230, v184, v185
    v_cvt_pk_bf16_f32 v231, v186, v187
    v_mfma_f32_16x16x32_bf16 v[68:71], v[72:75], v[124:127], v[68:71]
    v_cvt_pk_bf16_f32 v232, v188, v189
    v_cvt_pk_bf16_f32 v233, v190, v191
    v_subrev_u32 v24, 64, v24
    v_subrev_u32 v26, 64, v26
    s_waitcnt lgkmcnt(0)
    v_mfma_f32_16x16x32_bf16 v[40:43], v[80:83], v[128:131], v[40:43]
    ds_read_b64 v[72:73], v24 offset:512
    v_cvt_pk_bf16_f32 v234, v192, v193
    v_cvt_pk_bf16_f32 v235, v194, v195
    v_mfma_f32_16x16x32_bf16 v[44:47], v[84:87], v[128:131], v[44:47]
    ds_read_b64 v[74:75], v24 offset:520
    ds_write_b128 v35, v[228:231] offset:6416
    ds_write_b128 v35, v[232:235] offset:6432
    v_mfma_f32_16x16x32_bf16 v[44:47], v[80:83], v[132:135], v[44:47]
    ds_read_b64 v[76:77], v24 offset:0
    v_lshlrev_b32 v174, 16, v237
    v_mfma_f32_16x16x32_bf16 v[48:51], v[84:87], v[132:135], v[48:51]
    ds_read_b64 v[78:79], v24 offset:8
    v_and_b32 v175, 0xffff0000, v237
    v_lshlrev_b32 v176, 16, v240
    v_mfma_f32_16x16x32_bf16 v[48:51], v[80:83], v[136:139], v[48:51]
    ds_read_b128 v[96:99], v26 offset:0
    v_and_b32 v177, 0xffff0000, v240
    v_lshlrev_b32 v178, 16, v241
    v_mfma_f32_16x16x32_bf16 v[52:55], v[84:87], v[136:139], v[52:55]
    ds_read_b128 v[100:103], v26 offset:512
    v_and_b32 v179, 0xffff0000, v241
    v_lshlrev_b32 v180, 16, v242
    v_mfma_f32_16x16x32_bf16 v[52:55], v[80:83], v[140:143], v[52:55]
    ds_read_b128 v[104:107], v26 offset:1024
    v_and_b32 v181, 0xffff0000, v242
    v_mfma_f32_16x16x32_bf16 v[56:59], v[84:87], v[140:143], v[56:59]
    ds_read_b128 v[108:111], v26 offset:1536
    v_lshlrev_b32 v182, 16, v243
    v_and_b32 v183, 0xffff0000, v243
    v_mfma_f32_16x16x32_bf16 v[56:59], v[80:83], v[144:147], v[56:59]
    ds_read_b128 v[112:115], v26 offset:2048
    v_lshlrev_b32 v184, 16, v238
    v_and_b32 v185, 0xffff0000, v238
    v_mfma_f32_16x16x32_bf16 v[60:63], v[84:87], v[144:147], v[60:63]
    ds_read_b128 v[116:119], v26 offset:2560
    v_add_f32 v198, v174, v175
    v_add_f32 v199, v175, v176
    v_mfma_f32_16x16x32_bf16 v[60:63], v[80:83], v[148:151], v[60:63]
    ds_read_b128 v[120:123], v26 offset:3072
    v_add_f32 v200, v176, v177
    v_add_f32 v201, v177, v178
    v_mfma_f32_16x16x32_bf16 v[64:67], v[84:87], v[148:151], v[64:67]
    ds_read_b128 v[124:127], v26 offset:3584
    v_add_f32 v202, v178, v179
    v_mfma_f32_16x16x32_bf16 v[64:67], v[80:83], v[152:155], v[64:67]
    v_add_f32 v203, v179, v180
    v_add_f32 v204, v180, v181
    v_mfma_f32_16x16x32_bf16 v[68:71], v[84:87], v[152:155], v[68:71]
    v_add_f32 v205, v181, v182
    v_add_f32 v206, v182, v183
    v_mfma_f32_16x16x32_bf16 v[68:71], v[80:83], v[156:159], v[68:71]
    v_add_f32 v207, v183, v184
    v_add_f32 v177, v199, v177
    v_subrev_u32 v24, 64, v24
    v_subrev_u32 v26, 64, v26
    s_waitcnt lgkmcnt(0)
    v_mfma_f32_16x16x32_bf16 v[40:43], v[72:75], v[96:99], v[40:43]
    ds_read_b64 v[80:81], v24 offset:512
    v_add_f32 v178, v200, v178
    v_add_f32 v179, v201, v179
    v_mfma_f32_16x16x32_bf16 v[44:47], v[76:79], v[96:99], v[44:47]
    ds_read_b64 v[82:83], v24 offset:520
    v_add_f32 v180, v202, v180
    v_mfma_f32_16x16x32_bf16 v[44:47], v[72:75], v[100:103], v[44:47]
    ds_read_b64 v[84:85], v24 offset:0
    v_add_f32 v181, v203, v181
    v_add_f32 v182, v204, v182
    v_mfma_f32_16x16x32_bf16 v[48:51], v[76:79], v[100:103], v[48:51]
    ds_read_b64 v[86:87], v24 offset:8
    v_add_f32 v183, v205, v183
    v_add_f32 v184, v206, v184
    v_mfma_f32_16x16x32_bf16 v[48:51], v[72:75], v[104:107], v[48:51]
    ds_read_b128 v[128:131], v26 offset:0
    v_add_f32 v185, v207, v185
    v_cvt_pk_bf16_f32 v220, v177, v178
    v_mfma_f32_16x16x32_bf16 v[52:55], v[76:79], v[104:107], v[52:55]
    ds_read_b128 v[132:135], v26 offset:512
    v_cvt_pk_bf16_f32 v221, v179, v180
    v_mfma_f32_16x16x32_bf16 v[52:55], v[72:75], v[108:111], v[52:55]
    ds_read_b128 v[136:139], v26 offset:1024
    v_cvt_pk_bf16_f32 v222, v181, v182
    v_cvt_pk_bf16_f32 v223, v183, v184
    v_mfma_f32_16x16x32_bf16 v[56:59], v[76:79], v[108:111], v[56:59]
    ds_read_b128 v[140:143], v26 offset:1536
    ds_write_b128 v36, v[220:223] offset:5264
    v_add_f32 v178, v198, v178
    v_mfma_f32_16x16x32_bf16 v[56:59], v[72:75], v[112:115], v[56:59]
    ds_read_b128 v[144:147], v26 offset:2048
    v_add_f32 v179, v199, v179
    v_add_f32 v180, v200, v180
    v_mfma_f32_16x16x32_bf16 v[60:63], v[76:79], v[112:115], v[60:63]
    ds_read_b128 v[148:151], v26 offset:2560
    v_add_f32 v181, v201, v181
    v_add_f32 v182, v202, v182
    v_mfma_f32_16x16x32_bf16 v[60:63], v[72:75], v[116:119], v[60:63]
    ds_read_b128 v[152:155], v26 offset:3072
    v_add_f32 v183, v203, v183
    v_mfma_f32_16x16x32_bf16 v[64:67], v[76:79], v[116:119], v[64:67]
    ds_read_b128 v[156:159], v26 offset:3584
    v_add_f32 v184, v204, v184
    v_add_f32 v185, v205, v185
    v_mfma_f32_16x16x32_bf16 v[64:67], v[72:75], v[120:123], v[64:67]
    v_cvt_pk_bf16_f32 v228, v178, v179
    v_cvt_pk_bf16_f32 v229, v180, v181
    v_mfma_f32_16x16x32_bf16 v[68:71], v[76:79], v[120:123], v[68:71]
    v_cvt_pk_bf16_f32 v230, v182, v183
    v_cvt_pk_bf16_f32 v231, v184, v185
    v_mfma_f32_16x16x32_bf16 v[68:71], v[72:75], v[124:127], v[68:71]
    ds_write_b128 v36, v[228:231] offset:2064
    s_waitcnt lgkmcnt(0)
    v_mfma_f32_16x16x32_bf16 v[40:43], v[80:83], v[128:131], v[40:43]
    ds_read_b64_tr_b16 v[96:97], v32 offset:6400
    ds_read_b64_tr_b16 v[98:99], v32 offset:6464
    v_mfma_f32_16x16x32_bf16 v[44:47], v[84:87], v[128:131], v[44:47]
    ds_read_b64_tr_b16 v[100:101], v32 offset:6912
    ds_read_b64_tr_b16 v[102:103], v32 offset:6976
    v_mfma_f32_16x16x32_bf16 v[44:47], v[80:83], v[132:135], v[44:47]
    ds_read_b64_tr_b16 v[104:105], v32 offset:7424
    ds_read_b64_tr_b16 v[106:107], v32 offset:7488
    v_mfma_f32_16x16x32_bf16 v[48:51], v[84:87], v[132:135], v[48:51]
    ds_read_b64_tr_b16 v[108:109], v32 offset:7936
    ds_read_b64_tr_b16 v[110:111], v32 offset:8000
    v_mfma_f32_16x16x32_bf16 v[48:51], v[80:83], v[136:139], v[48:51]
    ds_read_b64 v[112:113], v30 offset:192
    ds_read_b64 v[114:115], v30 offset:200
    v_mfma_f32_16x16x32_bf16 v[52:55], v[84:87], v[136:139], v[52:55]
    ds_read_b64 v[116:117], v30 offset:128
    ds_read_b64 v[118:119], v30 offset:136
    v_mfma_f32_16x16x32_bf16 v[52:55], v[80:83], v[140:143], v[52:55]
    ds_read_b64 v[120:121], v30 offset:64
    ds_read_b64 v[122:123], v30 offset:72
    v_mfma_f32_16x16x32_bf16 v[56:59], v[84:87], v[140:143], v[56:59]
    ds_read_b64 v[124:125], v30 offset:0
    ds_read_b64 v[126:127], v30 offset:8
    v_mfma_f32_16x16x32_bf16 v[56:59], v[80:83], v[144:147], v[56:59]
    ds_read_b64 v[160:161], v29 offset:320
    ds_read_b64 v[162:163], v29 offset:328
    v_mfma_f32_16x16x32_bf16 v[60:63], v[84:87], v[144:147], v[60:63]
    ds_read_b64 v[164:165], v29 offset:256
    ds_read_b64 v[166:167], v29 offset:264
    v_mfma_f32_16x16x32_bf16 v[60:63], v[80:83], v[148:151], v[60:63]
    ds_read_b64 v[168:169], v29 offset:192
    ds_read_b64 v[170:171], v29 offset:200
    v_mfma_f32_16x16x32_bf16 v[64:67], v[84:87], v[148:151], v[64:67]
    ds_read_b64 v[172:173], v29 offset:128
    ds_read_b64 v[174:175], v29 offset:136
    v_mfma_f32_16x16x32_bf16 v[64:67], v[80:83], v[152:155], v[64:67]
    ds_read_b64 v[176:177], v29 offset:64
    ds_read_b64 v[178:179], v29 offset:72
    v_mfma_f32_16x16x32_bf16 v[68:71], v[84:87], v[152:155], v[68:71]
    ds_read_b64 v[180:181], v29 offset:0
    ds_read_b64 v[182:183], v29 offset:8
    v_mfma_f32_16x16x32_bf16 v[68:71], v[80:83], v[156:159], v[68:71]
    s_add_u32 s42, s40, 512
    v_add_u32 v7, s42, v27
    s_waitcnt lgkmcnt(0)
    v_mfma_f32_16x16x32_bf16 v[56:59], v[96:99], v[112:115], v[56:59]
    ds_read_b64_tr_b16 v[184:185], v31 offset:0
    v_mfma_f32_16x16x32_bf16 v[60:63], v[96:99], v[116:119], v[60:63]
    ds_read_b64_tr_b16 v[186:187], v31 offset:32
    v_mfma_f32_16x16x32_bf16 v[60:63], v[100:103], v[112:115], v[60:63]
    ds_read_b64_tr_b16 v[188:189], v31 offset:256
    v_mfma_f32_16x16x32_bf16 v[64:67], v[96:99], v[120:123], v[64:67]
    ds_read_b64_tr_b16 v[190:191], v31 offset:288
    v_mfma_f32_16x16x32_bf16 v[64:67], v[100:103], v[116:119], v[64:67]
    ds_read_b64_tr_b16 v[192:193], v31 offset:512
    v_mfma_f32_16x16x32_bf16 v[64:67], v[104:107], v[112:115], v[64:67]
    ds_read_b64_tr_b16 v[194:195], v31 offset:544
    v_mfma_f32_16x16x32_bf16 v[68:71], v[96:99], v[124:127], v[68:71]
    ds_read_b64_tr_b16 v[196:197], v31 offset:768
    v_mfma_f32_16x16x32_bf16 v[68:71], v[100:103], v[120:123], v[68:71]
    ds_read_b64_tr_b16 v[198:199], v31 offset:800
    v_mfma_f32_16x16x32_bf16 v[68:71], v[104:107], v[116:119], v[68:71]
    ds_read_b64_tr_b16 v[200:201], v31 offset:1024
    v_mfma_f32_16x16x32_bf16 v[68:71], v[108:111], v[112:115], v[68:71]
    ds_read_b64_tr_b16 v[202:203], v31 offset:1056
    s_waitcnt lgkmcnt(8)
    v_mfma_f32_16x16x32_bf16 v[48:51], v[184:187], v[164:167], v[48:51]
    ds_read_b64_tr_b16 v[204:205], v31 offset:1280
    v_mfma_f32_16x16x32_bf16 v[52:55], v[184:187], v[172:175], v[52:55]
    ds_read_b64_tr_b16 v[206:207], v31 offset:1312
    v_mfma_f32_16x16x32_bf16 v[56:59], v[184:187], v[180:183], v[56:59]
    ds_read_b64_tr_b16 v[208:209], v31 offset:1536
    s_waitcnt lgkmcnt(9)
    v_mfma_f32_16x16x32_bf16 v[48:51], v[188:191], v[160:163], v[48:51]
    ds_read_b64_tr_b16 v[210:211], v31 offset:1568
    v_mfma_f32_16x16x32_bf16 v[52:55], v[188:191], v[168:171], v[52:55]
    ds_read_b64_tr_b16 v[212:213], v31 offset:1792
    v_mfma_f32_16x16x32_bf16 v[56:59], v[188:191], v[176:179], v[56:59]
    ds_read_b64_tr_b16 v[214:215], v31 offset:1824
    s_waitcnt lgkmcnt(10)
    v_mfma_f32_16x16x32_bf16 v[52:55], v[192:195], v[164:167], v[52:55]
    ds_read_b64_tr_b16 v[216:217], v31 offset:2048
    v_mfma_f32_16x16x32_bf16 v[56:59], v[192:195], v[172:175], v[56:59]
    ds_read_b64_tr_b16 v[218:219], v31 offset:2080
    v_mfma_f32_16x16x32_bf16 v[60:63], v[192:195], v[180:183], v[60:63]
    ds_read_b64_tr_b16 v[220:221], v31 offset:2304
    s_waitcnt lgkmcnt(11)
    v_mfma_f32_16x16x32_bf16 v[52:55], v[196:199], v[160:163], v[52:55]
    ds_read_b64_tr_b16 v[222:223], v31 offset:2336
    v_mfma_f32_16x16x32_bf16 v[56:59], v[196:199], v[168:171], v[56:59]
    ds_read_b64_tr_b16 v[224:225], v31 offset:2560
    v_mfma_f32_16x16x32_bf16 v[60:63], v[196:199], v[176:179], v[60:63]
    ds_read_b64_tr_b16 v[226:227], v31 offset:2592
    s_waitcnt lgkmcnt(12)
    v_mfma_f32_16x16x32_bf16 v[56:59], v[200:203], v[164:167], v[56:59]
    ds_read_b64_tr_b16 v[228:229], v31 offset:2816
    v_mfma_f32_16x16x32_bf16 v[60:63], v[200:203], v[172:175], v[60:63]
    ds_read_b64_tr_b16 v[230:231], v31 offset:2848
    v_mfma_f32_16x16x32_bf16 v[64:67], v[200:203], v[180:183], v[64:67]
    s_waitcnt lgkmcnt(12)
    v_mfma_f32_16x16x32_bf16 v[56:59], v[204:207], v[160:163], v[56:59]
    ds_read_b64 v[72:73], v7 offset:0
    v_mfma_f32_16x16x32_bf16 v[60:63], v[204:207], v[168:171], v[60:63]
    ds_read_b64 v[74:75], v7 offset:512
    v_mfma_f32_16x16x32_bf16 v[64:67], v[204:207], v[176:179], v[64:67]
    s_waitcnt lgkmcnt(12)
    v_mfma_f32_16x16x32_bf16 v[60:63], v[208:211], v[164:167], v[60:63]
    ds_read_b64 v[76:77], v7 offset:1024
    v_mfma_f32_16x16x32_bf16 v[64:67], v[208:211], v[172:175], v[64:67]
    ds_read_b64 v[78:79], v7 offset:1536
    v_mfma_f32_16x16x32_bf16 v[68:71], v[208:211], v[180:183], v[68:71]
    s_waitcnt lgkmcnt(12)
    v_mfma_f32_16x16x32_bf16 v[60:63], v[212:215], v[160:163], v[60:63]
    ds_read_b64 v[80:81], v7 offset:2048
    v_mfma_f32_16x16x32_bf16 v[64:67], v[212:215], v[168:171], v[64:67]
    ds_read_b64 v[82:83], v7 offset:2560
    v_mfma_f32_16x16x32_bf16 v[68:71], v[212:215], v[176:179], v[68:71]
    s_waitcnt lgkmcnt(12)
    v_mfma_f32_16x16x32_bf16 v[64:67], v[216:219], v[164:167], v[64:67]
    ds_read_b64 v[84:85], v7 offset:3072
    v_mfma_f32_16x16x32_bf16 v[68:71], v[216:219], v[172:175], v[68:71]
    ds_read_b64 v[86:87], v7 offset:3584
    s_waitcnt lgkmcnt(12)
    v_mfma_f32_16x16x32_bf16 v[64:67], v[220:223], v[160:163], v[64:67]
    v_mfma_f32_16x16x32_bf16 v[68:71], v[220:223], v[168:171], v[68:71]
    s_waitcnt lgkmcnt(10)
    v_mfma_f32_16x16x32_bf16 v[68:71], v[224:227], v[164:167], v[68:71]
    s_waitcnt lgkmcnt(8)
    v_mfma_f32_16x16x32_bf16 v[68:71], v[228:231], v[160:163], v[68:71]
    s_setprio 3
    v_lshlrev_b32 v15, 16, v15
    s_lshl_b32 s34, s38, 12
    s_add_u32 s34, s34, 8388608
    s_waitcnt lgkmcnt(0)
    v_lshlrev_b32 v128, 16, v72
    v_and_b32 v129, 0xffff0000, v72
    v_lshlrev_b32 v130, 16, v73
    v_and_b32 v131, 0xffff0000, v73
    v_fma_f32 v128, v128, v15, v40
    v_fma_f32 v129, v129, v15, v41
    v_fma_f32 v130, v130, v15, v42
    v_fma_f32 v131, v131, v15, v43
    v_cvt_pk_bf16_f32 v72, v128, v129
    v_cvt_pk_bf16_f32 v73, v130, v131
    v_lshlrev_b32 v132, 16, v74
    v_and_b32 v133, 0xffff0000, v74
    v_lshlrev_b32 v134, 16, v75
    v_and_b32 v135, 0xffff0000, v75
    v_fma_f32 v132, v132, v15, v44
    v_fma_f32 v133, v133, v15, v45
    v_fma_f32 v134, v134, v15, v46
    v_fma_f32 v135, v135, v15, v47
    v_cvt_pk_bf16_f32 v74, v132, v133
    v_cvt_pk_bf16_f32 v75, v134, v135
    s_nop 0
    v_permlane16_swap_b32 v72, v74
    v_permlane16_swap_b32 v73, v75
    buffer_store_dwordx4 v[72:75], v28, s[16:19], s34 offen offset:0 sc1
    v_lshlrev_b32 v136, 16, v76
    v_and_b32 v137, 0xffff0000, v76
    v_lshlrev_b32 v138, 16, v77
    v_and_b32 v139, 0xffff0000, v77
    v_fma_f32 v136, v136, v15, v48
    v_fma_f32 v137, v137, v15, v49
    v_fma_f32 v138, v138, v15, v50
    v_fma_f32 v139, v139, v15, v51
    v_cvt_pk_bf16_f32 v76, v136, v137
    v_cvt_pk_bf16_f32 v77, v138, v139
    v_lshlrev_b32 v140, 16, v78
    v_and_b32 v141, 0xffff0000, v78
    v_lshlrev_b32 v142, 16, v79
    v_and_b32 v143, 0xffff0000, v79
    v_fma_f32 v140, v140, v15, v52
    v_fma_f32 v141, v141, v15, v53
    v_fma_f32 v142, v142, v15, v54
    v_fma_f32 v143, v143, v15, v55
    v_cvt_pk_bf16_f32 v78, v140, v141
    v_cvt_pk_bf16_f32 v79, v142, v143
    s_nop 0
    v_permlane16_swap_b32 v76, v78
    v_permlane16_swap_b32 v77, v79
    buffer_store_dwordx4 v[76:79], v28, s[16:19], s34 offen offset:1024 sc1
    v_lshlrev_b32 v128, 16, v80
    v_and_b32 v129, 0xffff0000, v80
    v_lshlrev_b32 v130, 16, v81
    v_and_b32 v131, 0xffff0000, v81
    v_fma_f32 v128, v128, v15, v56
    v_fma_f32 v129, v129, v15, v57
    v_fma_f32 v130, v130, v15, v58
    v_fma_f32 v131, v131, v15, v59
    v_cvt_pk_bf16_f32 v80, v128, v129
    v_cvt_pk_bf16_f32 v81, v130, v131
    v_lshlrev_b32 v132, 16, v82
    v_and_b32 v133, 0xffff0000, v82
    v_lshlrev_b32 v134, 16, v83
    v_and_b32 v135, 0xffff0000, v83
    v_fma_f32 v132, v132, v15, v60
    v_fma_f32 v133, v133, v15, v61
    v_fma_f32 v134, v134, v15, v62
    v_fma_f32 v135, v135, v15, v63
    v_cvt_pk_bf16_f32 v82, v132, v133
    v_cvt_pk_bf16_f32 v83, v134, v135
    s_nop 0
    v_permlane16_swap_b32 v80, v82
    v_permlane16_swap_b32 v81, v83
    buffer_store_dwordx4 v[80:83], v28, s[16:19], s34 offen offset:2048 sc1
    v_lshlrev_b32 v136, 16, v84
    v_and_b32 v137, 0xffff0000, v84
    v_lshlrev_b32 v138, 16, v85
    v_and_b32 v139, 0xffff0000, v85
    v_fma_f32 v136, v136, v15, v64
    v_fma_f32 v137, v137, v15, v65
    v_fma_f32 v138, v138, v15, v66
    v_fma_f32 v139, v139, v15, v67
    v_cvt_pk_bf16_f32 v84, v136, v137
    v_cvt_pk_bf16_f32 v85, v138, v139
    v_lshlrev_b32 v140, 16, v86
    v_and_b32 v141, 0xffff0000, v86
    v_lshlrev_b32 v142, 16, v87
    v_and_b32 v143, 0xffff0000, v87
    v_fma_f32 v140, v140, v15, v68
    v_fma_f32 v141, v141, v15, v69
    v_fma_f32 v142, v142, v15, v70
    v_fma_f32 v143, v143, v15, v71
    v_cvt_pk_bf16_f32 v86, v140, v141
    v_cvt_pk_bf16_f32 v87, v142, v143
    s_nop 0
    v_permlane16_swap_b32 v84, v86
    v_permlane16_swap_b32 v85, v87
    buffer_store_dwordx4 v[84:87], v28, s[16:19], s34 offen offset:3072 sc1
    v_mov_b32 v2, 1
    v_mov_b32 v3, 163584
    s_mov_b64 exec, 1
    ds_add_u32 v3, v2 offset:12
    s_mov_b64 exec, -1
    s_bfe_u32 s40, s2, 0x10002
    s_lshl_b32 s40, s40, 3
    s_lshr_b32 s41, s2, 5
    s_add_u32 s40, s40, s41
    s_lshl_b32 s40, s40, 7
    s_lshl_b32 s41, s37, 12
    s_lshl_b32 s42, s37, 5
    v_lshrrev_b32 v6, 3, v0
    v_add_u32 v6, s42, v6
    v_lshlrev_b32 v6, 11, v6
    v_and_b32 v7, 7, v0
    v_bfe_u32 v8, v0, 4, 1
    v_lshlrev_b32 v8, 2, v8
    v_xor_b32 v7, v7, v8
    v_lshl_add_u32 v6, v7, 4, v6
    s_lshr_b32 s34, s38, 6
    s_lshl_b32 s34, s34, 7
    s_add_u32 s34, s34, 12883968
    s_mov_b32 s56, s24
    s_mov_b32 s57, s25
    s_mov_b32 s58, 0x200000
    s_mov_b32 s59, 0x00020000
L_lwc:
    ds_read_b32 v4, v3 offset:12
    s_waitcnt lgkmcnt(0)
    v_readfirstlane_b32 s94, v4
    s_nop 0
    s_cmp_ge_u32 s94, 4
    s_cbranch_scc1 L_loc
    s_sleep 1
    s_branch L_lwc
L_loc:
    s_add_u32 m0, s41, 79872
    s_add_u32 s43, s40, 786432
    buffer_load_dwordx4 v6, s[56:59], s43 offen offset:0 lds
    s_add_u32 s43, s40, 801792
    buffer_load_dwordx4 v6, s[56:59], s43 offen offset:1024 lds
    s_add_u32 s43, s40, 817152
    buffer_load_dwordx4 v6, s[56:59], s43 offen offset:2048 lds
    s_add_u32 s43, s40, 832512
    buffer_load_dwordx4 v6, s[56:59], s43 offen offset:3072 lds
    s_add_u32 m0, s41, 96256
    s_add_u32 s43, s40, 1048576
    buffer_load_dwordx4 v6, s[56:59], s43 offen offset:0 lds
    s_add_u32 s43, s40, 1063936
    buffer_load_dwordx4 v6, s[56:59], s43 offen offset:1024 lds
    s_add_u32 s43, s40, 1079296
    buffer_load_dwordx4 v6, s[56:59], s43 offen offset:2048 lds
    s_add_u32 s43, s40, 1094656
    buffer_load_dwordx4 v6, s[56:59], s43 offen offset:3072 lds
    s_add_u32 m0, s41, 112640
    s_add_u32 s43, s40, 1310720
    buffer_load_dwordx4 v6, s[56:59], s43 offen offset:0 lds
    s_add_u32 s43, s40, 1326080
    buffer_load_dwordx4 v6, s[56:59], s43 offen offset:1024 lds
    s_add_u32 s43, s40, 1341440
    buffer_load_dwordx4 v6, s[56:59], s43 offen offset:2048 lds
    s_add_u32 s43, s40, 1356800
    buffer_load_dwordx4 v6, s[56:59], s43 offen offset:3072 lds
    s_add_u32 m0, s41, 129024
    s_add_u32 s43, s40, 1572864
    buffer_load_dwordx4 v6, s[56:59], s43 offen offset:0 lds
    s_add_u32 s43, s40, 1588224
    buffer_load_dwordx4 v6, s[56:59], s43 offen offset:1024 lds
    s_add_u32 s43, s40, 1603584
    buffer_load_dwordx4 v6, s[56:59], s43 offen offset:2048 lds
    s_add_u32 s43, s40, 1618944
    buffer_load_dwordx4 v6, s[56:59], s43 offen offset:3072 lds
    s_add_u32 m0, s41, 145408
    s_add_u32 s43, s40, 1835008
    buffer_load_dwordx4 v6, s[56:59], s43 offen offset:0 lds
    s_add_u32 s43, s40, 1850368
    buffer_load_dwordx4 v6, s[56:59], s43 offen offset:1024 lds
    s_add_u32 s43, s40, 1865728
    buffer_load_dwordx4 v6, s[56:59], s43 offen offset:2048 lds
    s_add_u32 s43, s40, 1881088
    buffer_load_dwordx4 v6, s[56:59], s43 offen offset:3072 lds
    s_waitcnt vmcnt(0)
    s_mov_b64 exec, 1
    buffer_atomic_add v2, v20, s[16:19], s34 offen
    s_mov_b64 exec, -1
    s_mov_b64 exec, 1
    ds_add_u32 v3, v2 offset:16
    s_mov_b64 exec, -1
    s_waitcnt lgkmcnt(0)
    s_endpgm
L_end:
    s_endpgm
.section .rodata,"a"
.p2align 6
.amdhsa_kernel gated_mix__linear_attn_block__ssm_conv_s4d__prompt_kernel
  .amdhsa_next_free_vgpr 256
  .amdhsa_next_free_sgpr 102
  .amdhsa_accum_offset 256
  .amdhsa_group_segment_fixed_size 0
  .amdhsa_kernarg_size 112
  .amdhsa_user_sgpr_count 2
  .amdhsa_user_sgpr_kernarg_segment_ptr 1
  .amdhsa_system_sgpr_workgroup_id_x 1
.end_amdhsa_kernel
```
